```python
import torch

def _softmax(x, axis=-1):
    return torch.softmax(x, dim=axis)
def _gelu(x):
    return torch.nn.functional.gelu(x, approximate="tanh")
def _silu(x):
    return torch.nn.functional.silu(x)
def _sigmoid(x):
    return torch.sigmoid(x)
def _layernorm(x, axis=-1, eps=1e-5):
    m = x.mean(dim=axis, keepdim=True)
    v = x.var(dim=axis, keepdim=True, unbiased=False)
    return (x - m) / torch.sqrt(v + eps)
def _scatter_add(tgt, idx, src, axis=0):
    return tgt.clone().index_add_(axis, idx, src)
def _segment_sum(src, seg, n):
    out = torch.zeros((n,) + src.shape[1:], dtype=src.dtype)
    return out.index_add_(0, seg, src)
def _pad(x, pw):
    flat = tuple(v for pair in reversed(pw) for v in pair)
    return torch.nn.functional.pad(x, flat)

kernel_name = 'gated_mix__mha_block__moe_arch_mod__prompt'

def setup_inputs():

    _w = (lambda a: (lambda t: t.to(torch.bfloat16) if t.is_floating_point() else t)(torch.as_tensor(a)))
    def _A_setup():
        B, S, D, H = 1, 2048, 512, 32
        return {
            "x": _w((lambda *s: torch.randn(*s, dtype=torch.bfloat16) * 0.05)(B, S, D)),
            "wqkv": _w((lambda *s: torch.randn(*s, dtype=torch.bfloat16) * 0.8)(D, 3 * D)),
            "wo": _w((lambda *s: torch.randn(*s, dtype=torch.bfloat16) * 0.1)(D, D)),
        }
    _A_in = _A_setup()

    def _B_setup():
        B, S, D, F, C = 1, 2048, 512, 1376, 1
        return {
            "x": _w((lambda *s: torch.randn(*s, dtype=torch.bfloat16) * 0.05)(B, S, D)),
            "w_r": _w((lambda *s: torch.randn(*s, dtype=torch.bfloat16) * 3.2)(D)),
            "w_gate": _w((lambda *s: torch.randn(*s, dtype=torch.bfloat16) * 0.2)(D, F)),
            "w_up": _w((lambda *s: torch.randn(*s, dtype=torch.bfloat16) * 0.2)(D, F)),
            "w_down": _w((lambda *s: torch.randn(*s, dtype=torch.bfloat16) * 0.2)(F, D)),
        }
    _B_in = _B_setup()

    return {
        "A_x": _A_in["x"],
        "A_wqkv": _A_in["wqkv"],
        "A_wo": _A_in["wo"],
        "B_x": _B_in["x"],
        "B_w_r": _B_in["w_r"],
        "B_w_gate": _B_in["w_gate"],
        "B_w_up": _B_in["w_up"],
        "B_w_down": _B_in["w_down"],
        "gate_w": _w((lambda *s: torch.randn(*s, dtype=torch.bfloat16) * 0.05)(512) * 16.0),
    }

def reference(A_x, A_wqkv, A_wo, B_x, B_w_r, B_w_gate, B_w_up, B_w_down, gate_w):
    def _A_ref(x, wqkv, wo):
        B, S, D = x.shape
        H = 32
        Dh = D // H
        qkv = (lambda x, *d: x.permute(*d))((x @ wqkv).reshape(B, S, 3, H, Dh), 2, 0, 3, 1, 4)
        q, k, v = qkv[0], qkv[1], qkv[2]
        scores = torch.einsum("bhqd,bhkd->bhqk", q, k) * (Dh ** -0.5)
        p = _softmax(scores, axis=-1)
        o = torch.einsum("bhqk,bhkd->bhqd", p, v)
        return (lambda x, *d: x.permute(*d))(o, 0, 2, 1, 3).reshape(B, S, D) @ wo

    def _B_ref(x, w_r, w_gate, w_up, w_down):
        B, S, D = x.shape
        C = 1
        r = x @ w_r
        idx = torch.argsort(-r, axis=-1)[:, :C]
        idx_e = (lambda x, n, axis: torch.repeat_interleave(x, n, dim=axis))(idx.reshape(B, C, 1), D, axis=2)
        x_sel = (lambda x, i, axis: torch.take_along_dim(x, i, dim=axis))(x, idx_e, axis=1)
        g = _silu(x_sel @ w_gate)
        u = x_sel @ w_up
        y = (g * u) @ w_down
        r_sel = _sigmoid((lambda x, i, axis: torch.take_along_dim(x, i, dim=axis))(r, idx, axis=1))
        y = y * r_sel.reshape(B, C, 1)
        b_off = (torch.arange(B) * S).reshape(B, 1)
        flat_idx = (idx + b_off).reshape(B * C)
        zero = (x * 0.0).reshape(B * S, D)
        upd = _scatter_add(zero, flat_idx, y.reshape(B * C, D), axis=0)
        return x + upd.reshape(B, S, D)

    x = A_x
    g = _sigmoid((x * gate_w).sum(-1, keepdims=True))
    a = _A_ref(x, A_wqkv, A_wo)
    b = _B_ref(x, B_w_r, B_w_gate, B_w_up, B_w_down)
    return g * a + (1 - g) * b
```

```asm
; @launch grid=(256,1,1) block=(768,1,1) lds=163840
.amdgcn_target "amdgcn-amd-amdhsa--gfx950"
.text
.globl gated_mix__mha_block__moe_arch_mod__prompt_kernel
.p2align 8
.type gated_mix__mha_block__moe_arch_mod__prompt_kernel,@function
gated_mix__mha_block__moe_arch_mod__prompt_kernel:

    s_load_dwordx16 s[16:31], s[0:1], 0
    s_load_dwordx8 s[32:39], s[0:1], 64
    s_cmp_ge_u32 s2, 256
    s_cbranch_scc1 L_end
    v_lshrrev_b32 v1, 6, v0
    v_and_b32 v159, 63, v0
    s_getpc_b64 s[52:53]
L_pcref:
    s_bfe_u32 s7, s2, 0x40003
    s_lshr_b32 s13, s2, 7
    v_readfirstlane_b32 s3, v1
    s_and_b32 s12, s2, 7
    s_lshl_b32 s12, s12, 1
    s_or_b32 s6, s12, s13
    s_lshr_b32 s4, s7, 1
    s_and_b32 s5, s7, 1
    s_and_b32 s8, s2, 7
    s_and_b32 s15, s3, 3
    s_cmp_ge_u32 s3, 4
    s_cbranch_scc1 L_FR
    s_setprio 3
    v_lshrrev_b32 v2, 3, v159
    v_and_b32 v3, 7, v159
    v_lshrrev_b32 v4, 4, v159
    v_xor_b32 v5, v3, v4
    v_lshlrev_b32 v5, 4, v5
    v_lshl_add_u32 v10, v2, 10, v5
    v_xor_b32 v11, 0x2040, v10
    v_and_b32 v4, 1, v4
    v_lshlrev_b32 v4, 2, v4
    v_xor_b32 v5, v3, v4
    v_lshlrev_b32 v5, 4, v5
    v_mov_b32 v6, 0xc00
    v_mad_u32_u24 v12, v2, v6, v5
    v_add_u32 v13, 0x6000, v12
    s_lshl_b32 s60, s6, 2
    s_add_u32 s68, s60, s3
    s_lshl_b32 s60, s68, 15
    s_lshl_b32 s61, s5, 3
    s_add_u32 s61, s61, s4
    s_lshl_b32 s61, s61, 7
    s_mul_i32 s63, s3, 0xc000
    s_add_u32 s64, s61, s63
    s_add_u32 s64, s64, 0x400
    s_lshl_b32 s69, s3, 12
    s_lshl_b32 s62, s3, 11
    s_add_u32 s62, s62, 0x20000
    s_mov_b32 s67, s62
    s_mov_b32 s14, s8
    s_mov_b32 s10, 0
    s_mov_b32 s42, 0x200000
    s_mov_b32 s43, 0x20000
    s_mov_b32 s46, 0x180000
    s_mov_b32 s47, 0x20000
    s_waitcnt lgkmcnt(0)
    s_mov_b64 s[40:41], s[16:17]
    s_mov_b64 s[44:45], s[18:19]
    s_or_b32 s11, s2, s3
    s_cbranch_scc1 L_noepoch
    s_memrealtime s[12:13]
    s_mov_b64 s[52:53], s[36:37]
    s_mov_b32 s54, 0x100
    s_mov_b32 s55, 0x20000
    v_mov_b32 v21, 0
    s_waitcnt lgkmcnt(0)
    s_or_b32 s12, s12, 1
    v_mov_b32 v20, s12
    s_mov_b64 exec, 1
    buffer_atomic_cmpswap v[20:21], v21, s[52:55], 0 offen sc1
    s_mov_b64 exec, -1
L_noepoch:
L_dma1:
    s_lshl_b32 s11, s14, 7
    s_add_u32 s11, s11, s60
    s_mov_b32 m0, s69
    s_mul_i32 s12, s14, 0x30000
    buffer_load_dwordx4 v10, s[40:43], s11 offen lds
    s_add_u32 m0, s69, 0x400
    s_add_u32 s12, s12, s64
    buffer_load_dwordx4 v11, s[40:43], s11 offen lds
    s_add_u32 m0, s69, 0x800
    s_add_u32 s11, s11, 0x4000
    buffer_load_dwordx4 v10, s[40:43], s11 offen lds
    s_add_u32 m0, s69, 0xc00
    s_add_u32 s69, s69, 0x4000
    buffer_load_dwordx4 v11, s[40:43], s11 offen lds
    s_cmp_lt_u32 s10, 2
    s_cbranch_scc1 L_dma1g
    s_waitcnt vmcnt(10)
    s_barrier
L_dma1g:
    s_mov_b32 m0, s67
    s_add_u32 s14, s14, 1
    buffer_load_dwordx4 v12, s[44:47], s12 offen lds
    s_add_u32 m0, s67, 0x400
    s_and_b32 s14, s14, 7
    buffer_load_dwordx4 v13, s[44:47], s12 offen lds
    s_add_u32 s67, s67, 0x2000
    s_cmp_ge_u32 s67, 0x26000
    s_cselect_b32 s67, s62, s67
    s_add_u32 s10, s10, 1
    s_cmp_lt_u32 s10, 8
    s_cbranch_scc1 L_dma1
    s_branch L_h2
L_FR:
    s_cmp_lt_u32 s3, 8
    s_cbranch_scc1 L_F
    s_lshr_b32 s13, s2, 3
    s_mul_i32 s13, s13, 3
    s_add_u32 s13, s13, s15
    s_lshl_b32 s13, s13, 8
    s_add_u32 s13, s13, 3840
    s_cmp_eq_u32 s15, 0
    s_cselect_b32 s13, 0, s13
    s_cselect_b32 s12, -1, 3
    v_lshl_add_u32 v108, v159, 7, s13
    v_min_u32 v108, L_end-L_pcref, v108
    s_mov_b32 exec_lo, s12
    s_mov_b32 exec_hi, 0
    global_load_dword v109, v108, s[52:53]
    s_mov_b64 exec, -1
    v_mov_b32 v110, 0
    v_lshlrev_b32 v8, 2, v159
    v_add_u32 v8, 162816, v8
    ds_write_b32 v8, v110
    v_and_b32 v2, 31, v159
    v_lshrrev_b32 v3, 5, v159
    v_bfe_u32 v4, v159, 1, 3
    v_xor_b32 v4, v4, v3
    v_lshlrev_b32 v4, 4, v4
    v_lshl_add_u32 v160, v2, 7, v4
    s_and_b32 s69, s15, 1
    s_lshr_b32 s68, s15, 1
    s_lshl_b32 s11, s69, 12
    v_add_u32 v160, s11, v160
    v_bfe_u32 v2, v159, 2, 2
    v_lshl_add_u32 v6, v3, 3, v2
    v_bfe_u32 v5, v159, 4, 1
    v_and_b32 v7, 3, v159
    v_lshlrev_b32 v7, 3, v7
    v_lshl_add_u32 v7, v5, 5, v7
    v_and_b32 v166, 3, v159
    v_lshlrev_b32 v166, 2, v166
    v_add_u32 v166, 162816, v166
    s_lshl_b32 s11, s3, 2
    s_add_u32 s11, s11, 162816
    v_mov_b32 v165, s11
    s_waitcnt lgkmcnt(0)
    s_mov_b64 s[52:53], s[36:37]
    s_mov_b32 s54, 0x100
    s_mov_b32 s55, 0x20000
    v_mov_b32 v146, 0
    s_lshl_b32 s11, s68, 13
    v_add_u32 v80, s11, v160
    v_xor_b32 v81, 32, v80
    v_xor_b32 v82, 64, v80
    v_xor_b32 v83, 0x60, v80
    v_lshl_add_u32 v85, v6, 6, v7
    v_add_u32 v84, 0x20000, v85
    s_add_u32 s12, s7, 1
    s_and_b32 s12, s12, 15
    s_lshl_b32 s12, s12, 10
    s_add_u32 s12, s12, 0x4000
    v_add_u32 v85, s12, v85
    v_lshlrev_b32 v163, 4, v159
    s_lshl_b32 s12, s15, 12
    v_add_u32 v86, s12, v163
    s_nop 0
    s_mov_b64 s[48:49], s[38:39]
    s_mov_b32 s50, 0xa00000
    s_mov_b32 s51, 0x20000
    s_getreg_b32 s93, hwreg(HW_REG_XCC_ID, 0, 4)
    s_and_b32 s10, s2, 7
    s_lshl_b32 s10, s10, 8
    s_add_u32 s10, s10, 0x890000
    v_and_b32 v2, 31, v159
    v_lshl_add_u32 v89, v2, 3, s10
    s_lshr_b32 s11, s2, 3
    s_lshl_b32 s11, s11, 3
    s_add_u32 s10, s10, s11
    v_mov_b32 v90, s10
    s_barrier
    s_cmp_lg_u32 s3, 11
    s_cbranch_scc1 n11_35
    buffer_load_dword v3, v110, s[52:55], 0 offen sc0 sc1
n11_35:
    s_barrier
    ds_read_b128 v[16:19], v80 offset:0
    ds_read_b128 v[20:23], v81 offset:0
    ds_read_b128 v[24:27], v82 offset:0
    ds_read_b128 v[28:31], v83 offset:0
    ds_read_b128 v[48:51], v80 offset:16384
    ds_read_b128 v[52:55], v81 offset:16384
    ds_read_b128 v[56:59], v82 offset:16384
    ds_read_b128 v[60:63], v83 offset:16384
    s_waitcnt lgkmcnt(0)
    s_barrier
    s_cmp_lg_u32 s3, 11
    s_cbranch_scc1 n11_36
    s_mov_b32 s76, 0
L_tag:
    s_waitcnt vmcnt(0)
    v_readfirstlane_b32 s9, v3
    s_add_u32 s76, s76, 1
    s_cmp_lg_u32 s9, 0
    s_cbranch_scc1 L_tagok
    buffer_load_dword v3, v110, s[52:55], 0 offen sc0 sc1
    s_cmp_lt_u32 s76, 40000
    s_cbranch_scc1 L_tag
    s_waitcnt vmcnt(0)
L_tagok:
    v_mov_b32 v2, s93
    s_mov_b64 exec, 1
    buffer_store_dwordx2 v[2:3], v90, s[48:51], 0 offen sc1
    s_mov_b64 exec, 15
    ds_write_b32 v166, v3 offset:48
    s_mov_b64 exec, -1
n11_36:
    s_barrier
    s_barrier
    s_barrier
    s_cmp_lg_u32 s3, 11
    s_cbranch_scc1 n11_37
    buffer_load_dwordx2 v[108:109], v89, s[48:51], 0 offen sc1
n11_37:
    s_barrier
    s_branch L_R
L_F:
    v_and_b32 v2, 31, v159
    v_lshrrev_b32 v3, 5, v159
    v_bfe_u32 v4, v159, 1, 3
    v_xor_b32 v4, v4, v3
    v_lshlrev_b32 v4, 4, v4
    v_lshl_add_u32 v160, v2, 7, v4
    s_and_b32 s69, s15, 1
    s_lshr_b32 s68, s15, 1
    s_lshl_b32 s11, s69, 12
    v_add_u32 v160, s11, v160
    v_bfe_u32 v2, v159, 2, 2
    v_lshl_add_u32 v6, v3, 3, v2
    v_bfe_u32 v5, v159, 4, 1
    v_and_b32 v7, 3, v159
    v_lshlrev_b32 v7, 3, v7
    v_lshl_add_u32 v7, v5, 5, v7
    v_xor_b32 v161, 32, v160
    v_xor_b32 v162, 64, v160
    v_xor_b32 v163, 0x60, v160
    v_lshl_add_u32 v4, v6, 7, v7
    v_lshrrev_b32 v2, 1, v2
    v_xor_b32 v2, s68, v2
    v_lshl_add_u32 v4, v2, 6, v4
    v_add_u32 v158, 0x20000, v4
    v_and_b32 v2, 0x33, v159
    v_bfe_u32 v4, v159, 2, 1
    v_lshl_or_b32 v2, v4, 3, v2
    v_bfe_u32 v4, v159, 3, 1
    v_lshl_or_b32 v2, v4, 2, v2
    v_lshlrev_b32 v157, 4, v2
    v_and_b32 v2, 15, v159
    v_lshlrev_b32 v2, 4, v2
    v_lshl_add_u32 v2, v3, 8, v2
    v_lshl_add_u32 v4, v5, 17, v2
    v_add_u32 v4, 0x400, v4
    s_cmp_eq_u32 s5, 1
    s_cselect_b64 vcc, -1, 0
    s_movk_i32 s67, 0x200
    s_cselect_b32 s67, s67, 0x20000
    v_cndmask_b32 v157, v157, v4, vcc
    s_lshl_b32 s66, s4, 1
    s_add_u32 s66, s66, s68
    s_lshl_b32 s66, s66, 18
    s_lshl_b32 s11, s6, 1
    s_add_u32 s11, s11, s69
    s_lshl_b32 s11, s11, 12
    s_add_u32 s66, s66, s11
    s_add_u32 s67, s67, s66
    s_waitcnt lgkmcnt(0)
    s_mov_b64 s[48:49], s[38:39]
    s_mov_b32 s50, 0xa00000
    s_mov_b32 s51, 0x20000
    s_cbranch_vccnz L_gV
    s_barrier
    ds_read_b64_tr_b16 v[64:65], v158 offset:0
    ds_read_b64_tr_b16 v[66:67], v158 offset:512
    ds_read_b128 v[32:35], v160 offset:0
    ds_read_b128 v[48:51], v160 offset:8192
    ds_read_b64_tr_b16 v[68:69], v158 offset:2048
    ds_read_b64_tr_b16 v[70:71], v158 offset:2560
    ds_read_b128 v[36:39], v161 offset:0
    ds_read_b128 v[52:55], v161 offset:8192
    ds_read_b64_tr_b16 v[72:73], v158 offset:4096
    ds_read_b64_tr_b16 v[74:75], v158 offset:4608
    ds_read_b128 v[40:43], v162 offset:0
    ds_read_b128 v[56:59], v162 offset:8192
    ds_read_b64_tr_b16 v[76:77], v158 offset:6144
    ds_read_b64_tr_b16 v[78:79], v158 offset:6656
    ds_read_b128 v[44:47], v163 offset:0
    ds_read_b128 v[60:63], v163 offset:8192
    s_waitcnt lgkmcnt(0)
    s_barrier
    v_mfma_f32_32x32x16_bf16 v[0:15], v[64:67], v[32:35], 0
    ds_read_b64_tr_b16 v[112:113], v158 offset:8192
    ds_read_b64_tr_b16 v[114:115], v158 offset:8704
    ds_read_b128 v[80:83], v160 offset:16384
    ds_read_b128 v[96:99], v160 offset:24576
    v_mfma_f32_32x32x16_bf16 v[16:31], v[64:67], v[48:51], 0
    ds_read_b64_tr_b16 v[116:117], v158 offset:10240
    ds_read_b64_tr_b16 v[118:119], v158 offset:10752
    ds_read_b128 v[84:87], v161 offset:16384
    ds_read_b128 v[100:103], v161 offset:24576
    v_mfma_f32_32x32x16_bf16 v[0:15], v[68:71], v[36:39], v[0:15]
    ds_read_b64_tr_b16 v[120:121], v158 offset:12288
    ds_read_b64_tr_b16 v[122:123], v158 offset:12800
    v_mfma_f32_32x32x16_bf16 v[16:31], v[68:71], v[52:55], v[16:31]
    ds_read_b128 v[88:91], v162 offset:16384
    ds_read_b128 v[104:107], v162 offset:24576
    v_mfma_f32_32x32x16_bf16 v[0:15], v[72:75], v[40:43], v[0:15]
    ds_read_b64_tr_b16 v[124:125], v158 offset:14336
    ds_read_b64_tr_b16 v[126:127], v158 offset:14848
    v_mfma_f32_32x32x16_bf16 v[16:31], v[72:75], v[56:59], v[16:31]
    ds_read_b128 v[92:95], v163 offset:16384
    ds_read_b128 v[108:111], v163 offset:24576
    v_mfma_f32_32x32x16_bf16 v[0:15], v[76:79], v[44:47], v[0:15]
    v_mfma_f32_32x32x16_bf16 v[16:31], v[76:79], v[60:63], v[16:31]
    s_waitcnt lgkmcnt(0)
    s_barrier
    v_mfma_f32_32x32x16_bf16 v[0:15], v[112:115], v[80:83], v[0:15]
    ds_read_b64_tr_b16 v[64:65], v158 offset:16384
    ds_read_b64_tr_b16 v[66:67], v158 offset:16896
    ds_read_b128 v[32:35], v160 offset:32768
    ds_read_b128 v[48:51], v160 offset:40960
    v_mfma_f32_32x32x16_bf16 v[16:31], v[112:115], v[96:99], v[16:31]
    ds_read_b64_tr_b16 v[68:69], v158 offset:18432
    ds_read_b64_tr_b16 v[70:71], v158 offset:18944
    ds_read_b128 v[36:39], v161 offset:32768
    ds_read_b128 v[52:55], v161 offset:40960
    v_mfma_f32_32x32x16_bf16 v[0:15], v[116:119], v[84:87], v[0:15]
    ds_read_b64_tr_b16 v[72:73], v158 offset:20480
    ds_read_b64_tr_b16 v[74:75], v158 offset:20992
    v_mfma_f32_32x32x16_bf16 v[16:31], v[116:119], v[100:103], v[16:31]
    ds_read_b128 v[40:43], v162 offset:32768
    ds_read_b128 v[56:59], v162 offset:40960
    v_mfma_f32_32x32x16_bf16 v[0:15], v[120:123], v[88:91], v[0:15]
    ds_read_b64_tr_b16 v[76:77], v158 offset:22528
    ds_read_b64_tr_b16 v[78:79], v158 offset:23040
    v_mfma_f32_32x32x16_bf16 v[16:31], v[120:123], v[104:107], v[16:31]
    ds_read_b128 v[44:47], v163 offset:32768
    ds_read_b128 v[60:63], v163 offset:40960
    v_mfma_f32_32x32x16_bf16 v[0:15], v[124:127], v[92:95], v[0:15]
    v_mfma_f32_32x32x16_bf16 v[16:31], v[124:127], v[108:111], v[16:31]
    s_waitcnt lgkmcnt(0)
    s_barrier
    v_mfma_f32_32x32x16_bf16 v[0:15], v[64:67], v[32:35], v[0:15]
    ds_read_b64_tr_b16 v[112:113], v158 offset:0
    ds_read_b64_tr_b16 v[114:115], v158 offset:512
    ds_read_b128 v[80:83], v160 offset:49152
    ds_read_b128 v[96:99], v160 offset:57344
    v_mfma_f32_32x32x16_bf16 v[16:31], v[64:67], v[48:51], v[16:31]
    ds_read_b64_tr_b16 v[116:117], v158 offset:2048
    ds_read_b64_tr_b16 v[118:119], v158 offset:2560
    ds_read_b128 v[84:87], v161 offset:49152
    ds_read_b128 v[100:103], v161 offset:57344
    v_mfma_f32_32x32x16_bf16 v[0:15], v[68:71], v[36:39], v[0:15]
    ds_read_b64_tr_b16 v[120:121], v158 offset:4096
    ds_read_b64_tr_b16 v[122:123], v158 offset:4608
    v_mfma_f32_32x32x16_bf16 v[16:31], v[68:71], v[52:55], v[16:31]
    ds_read_b128 v[88:91], v162 offset:49152
    ds_read_b128 v[104:107], v162 offset:57344
    v_mfma_f32_32x32x16_bf16 v[0:15], v[72:75], v[40:43], v[0:15]
    ds_read_b64_tr_b16 v[124:125], v158 offset:6144
    ds_read_b64_tr_b16 v[126:127], v158 offset:6656
    v_mfma_f32_32x32x16_bf16 v[16:31], v[72:75], v[56:59], v[16:31]
    ds_read_b128 v[92:95], v163 offset:49152
    ds_read_b128 v[108:111], v163 offset:57344
    v_mfma_f32_32x32x16_bf16 v[0:15], v[76:79], v[44:47], v[0:15]
    v_mfma_f32_32x32x16_bf16 v[16:31], v[76:79], v[60:63], v[16:31]
    v_add_u32 v160, 0x10000, v160
    v_add_u32 v161, 0x10000, v161
    v_add_u32 v162, 0x10000, v162
    v_add_u32 v163, 0x10000, v163
    s_waitcnt lgkmcnt(0)
    s_barrier
    v_mfma_f32_32x32x16_bf16 v[0:15], v[112:115], v[80:83], v[0:15]
    ds_read_b64_tr_b16 v[64:65], v158 offset:8192
    ds_read_b64_tr_b16 v[66:67], v158 offset:8704
    ds_read_b128 v[32:35], v160 offset:0
    ds_read_b128 v[48:51], v160 offset:8192
    v_mfma_f32_32x32x16_bf16 v[16:31], v[112:115], v[96:99], v[16:31]
    ds_read_b64_tr_b16 v[68:69], v158 offset:10240
    ds_read_b64_tr_b16 v[70:71], v158 offset:10752
    ds_read_b128 v[36:39], v161 offset:0
    ds_read_b128 v[52:55], v161 offset:8192
    v_mfma_f32_32x32x16_bf16 v[0:15], v[116:119], v[84:87], v[0:15]
    ds_read_b64_tr_b16 v[72:73], v158 offset:12288
    ds_read_b64_tr_b16 v[74:75], v158 offset:12800
    v_mfma_f32_32x32x16_bf16 v[16:31], v[116:119], v[100:103], v[16:31]
    ds_read_b128 v[40:43], v162 offset:0
    ds_read_b128 v[56:59], v162 offset:8192
    v_mfma_f32_32x32x16_bf16 v[0:15], v[120:123], v[88:91], v[0:15]
    ds_read_b64_tr_b16 v[76:77], v158 offset:14336
    ds_read_b64_tr_b16 v[78:79], v158 offset:14848
    v_mfma_f32_32x32x16_bf16 v[16:31], v[120:123], v[104:107], v[16:31]
    ds_read_b128 v[44:47], v163 offset:0
    ds_read_b128 v[60:63], v163 offset:8192
    v_mfma_f32_32x32x16_bf16 v[0:15], v[124:127], v[92:95], v[0:15]
    v_mfma_f32_32x32x16_bf16 v[16:31], v[124:127], v[108:111], v[16:31]
    s_waitcnt lgkmcnt(0)
    s_barrier
    v_mfma_f32_32x32x16_bf16 v[0:15], v[64:67], v[32:35], v[0:15]
    ds_read_b64_tr_b16 v[112:113], v158 offset:16384
    ds_read_b64_tr_b16 v[114:115], v158 offset:16896
    ds_read_b128 v[80:83], v160 offset:16384
    ds_read_b128 v[96:99], v160 offset:24576
    v_mfma_f32_32x32x16_bf16 v[16:31], v[64:67], v[48:51], v[16:31]
    ds_read_b64_tr_b16 v[116:117], v158 offset:18432
    ds_read_b64_tr_b16 v[118:119], v158 offset:18944
    ds_read_b128 v[84:87], v161 offset:16384
    ds_read_b128 v[100:103], v161 offset:24576
    v_mfma_f32_32x32x16_bf16 v[0:15], v[68:71], v[36:39], v[0:15]
    ds_read_b64_tr_b16 v[120:121], v158 offset:20480
    ds_read_b64_tr_b16 v[122:123], v158 offset:20992
    v_mfma_f32_32x32x16_bf16 v[16:31], v[68:71], v[52:55], v[16:31]
    ds_read_b128 v[88:91], v162 offset:16384
    ds_read_b128 v[104:107], v162 offset:24576
    v_mfma_f32_32x32x16_bf16 v[0:15], v[72:75], v[40:43], v[0:15]
    ds_read_b64_tr_b16 v[124:125], v158 offset:22528
    ds_read_b64_tr_b16 v[126:127], v158 offset:23040
    v_mfma_f32_32x32x16_bf16 v[16:31], v[72:75], v[56:59], v[16:31]
    ds_read_b128 v[92:95], v163 offset:16384
    ds_read_b128 v[108:111], v163 offset:24576
    v_mfma_f32_32x32x16_bf16 v[0:15], v[76:79], v[44:47], v[0:15]
    v_mfma_f32_32x32x16_bf16 v[16:31], v[76:79], v[60:63], v[16:31]
    s_waitcnt lgkmcnt(0)
    s_barrier
    v_mfma_f32_32x32x16_bf16 v[0:15], v[112:115], v[80:83], v[0:15]
    ds_read_b64_tr_b16 v[64:65], v158 offset:0
    ds_read_b64_tr_b16 v[66:67], v158 offset:512
    ds_read_b128 v[32:35], v160 offset:32768
    ds_read_b128 v[48:51], v160 offset:40960
    v_mfma_f32_32x32x16_bf16 v[16:31], v[112:115], v[96:99], v[16:31]
    ds_read_b64_tr_b16 v[68:69], v158 offset:2048
    ds_read_b64_tr_b16 v[70:71], v158 offset:2560
    ds_read_b128 v[36:39], v161 offset:32768
    ds_read_b128 v[52:55], v161 offset:40960
    v_mfma_f32_32x32x16_bf16 v[0:15], v[116:119], v[84:87], v[0:15]
    ds_read_b64_tr_b16 v[72:73], v158 offset:4096
    ds_read_b64_tr_b16 v[74:75], v158 offset:4608
    v_mfma_f32_32x32x16_bf16 v[16:31], v[116:119], v[100:103], v[16:31]
    ds_read_b128 v[40:43], v162 offset:32768
    ds_read_b128 v[56:59], v162 offset:40960
    v_mfma_f32_32x32x16_bf16 v[0:15], v[120:123], v[88:91], v[0:15]
    ds_read_b64_tr_b16 v[76:77], v158 offset:6144
    ds_read_b64_tr_b16 v[78:79], v158 offset:6656
    v_mfma_f32_32x32x16_bf16 v[16:31], v[120:123], v[104:107], v[16:31]
    ds_read_b128 v[44:47], v163 offset:32768
    ds_read_b128 v[60:63], v163 offset:40960
    v_mfma_f32_32x32x16_bf16 v[0:15], v[124:127], v[92:95], v[0:15]
    v_mfma_f32_32x32x16_bf16 v[16:31], v[124:127], v[108:111], v[16:31]
    s_waitcnt lgkmcnt(0)
    v_mfma_f32_32x32x16_bf16 v[0:15], v[64:67], v[32:35], v[0:15]
    v_mfma_f32_32x32x16_bf16 v[16:31], v[64:67], v[48:51], v[16:31]
    v_mfma_f32_32x32x16_bf16 v[0:15], v[68:71], v[36:39], v[0:15]
    v_mfma_f32_32x32x16_bf16 v[16:31], v[68:71], v[52:55], v[16:31]
    v_mfma_f32_32x32x16_bf16 v[0:15], v[72:75], v[40:43], v[0:15]
    v_mfma_f32_32x32x16_bf16 v[16:31], v[72:75], v[56:59], v[16:31]
    v_mfma_f32_32x32x16_bf16 v[0:15], v[76:79], v[44:47], v[0:15]
    v_mfma_f32_32x32x16_bf16 v[16:31], v[76:79], v[60:63], v[16:31]
    s_barrier
    ds_read_b64_tr_b16 v[112:113], v158 offset:8192
    ds_read_b64_tr_b16 v[114:115], v158 offset:8704
    ds_read_b128 v[80:83], v160 offset:49152
    ds_read_b64_tr_b16 v[116:117], v158 offset:10240
    ds_read_b64_tr_b16 v[118:119], v158 offset:10752
    ds_read_b128 v[84:87], v161 offset:49152
    ds_read_b64_tr_b16 v[120:121], v158 offset:12288
    ds_read_b64_tr_b16 v[122:123], v158 offset:12800
    ds_read_b128 v[88:91], v162 offset:49152
    ds_read_b64_tr_b16 v[124:125], v158 offset:14336
    ds_read_b64_tr_b16 v[126:127], v158 offset:14848
    ds_read_b128 v[92:95], v163 offset:49152
    ds_read_b128 v[96:99], v160 offset:57344
    ds_read_b128 v[100:103], v161 offset:57344
    ds_read_b128 v[104:107], v162 offset:57344
    ds_read_b128 v[108:111], v163 offset:57344
    s_waitcnt lgkmcnt(13)
    v_mfma_f32_32x32x16_bf16 v[0:15], v[112:115], v[80:83], v[0:15]
    s_waitcnt lgkmcnt(10)
    v_mfma_f32_32x32x16_bf16 v[0:15], v[116:119], v[84:87], v[0:15]
    s_waitcnt lgkmcnt(7)
    v_mfma_f32_32x32x16_bf16 v[0:15], v[120:123], v[88:91], v[0:15]
    s_waitcnt lgkmcnt(4)
    v_mfma_f32_32x32x16_bf16 v[0:15], v[124:127], v[92:95], v[0:15]
    s_barrier
    s_waitcnt lgkmcnt(3)
    v_mfma_f32_32x32x16_bf16 v[16:31], v[112:115], v[96:99], v[16:31]
    s_waitcnt lgkmcnt(2)
    v_mfma_f32_32x32x16_bf16 v[16:31], v[116:119], v[100:103], v[16:31]
    s_waitcnt lgkmcnt(1)
    v_mfma_f32_32x32x16_bf16 v[16:31], v[120:123], v[104:107], v[16:31]
    s_waitcnt lgkmcnt(0)
    v_mfma_f32_32x32x16_bf16 v[16:31], v[124:127], v[108:111], v[16:31]
    s_branch L_genE
L_gV:
    s_barrier
    ds_read_b64_tr_b16 v[64:65], v158 offset:0
    ds_read_b64_tr_b16 v[66:67], v158 offset:512
    ds_read_b128 v[32:35], v160 offset:0
    ds_read_b128 v[48:51], v160 offset:8192
    ds_read_b64_tr_b16 v[68:69], v158 offset:2048
    ds_read_b64_tr_b16 v[70:71], v158 offset:2560
    ds_read_b128 v[36:39], v161 offset:0
    ds_read_b128 v[52:55], v161 offset:8192
    ds_read_b64_tr_b16 v[72:73], v158 offset:4096
    ds_read_b64_tr_b16 v[74:75], v158 offset:4608
    ds_read_b128 v[40:43], v162 offset:0
    ds_read_b128 v[56:59], v162 offset:8192
    ds_read_b64_tr_b16 v[76:77], v158 offset:6144
    ds_read_b64_tr_b16 v[78:79], v158 offset:6656
    ds_read_b128 v[44:47], v163 offset:0
    ds_read_b128 v[60:63], v163 offset:8192
    s_waitcnt lgkmcnt(0)
    s_barrier
    v_mfma_f32_32x32x16_bf16 v[0:15], v[32:35], v[64:67], 0
    ds_read_b64_tr_b16 v[112:113], v158 offset:8192
    ds_read_b64_tr_b16 v[114:115], v158 offset:8704
    ds_read_b128 v[80:83], v160 offset:16384
    ds_read_b128 v[96:99], v160 offset:24576
    v_mfma_f32_32x32x16_bf16 v[16:31], v[48:51], v[64:67], 0
    ds_read_b64_tr_b16 v[116:117], v158 offset:10240
    ds_read_b64_tr_b16 v[118:119], v158 offset:10752
    ds_read_b128 v[84:87], v161 offset:16384
    ds_read_b128 v[100:103], v161 offset:24576
    v_mfma_f32_32x32x16_bf16 v[0:15], v[36:39], v[68:71], v[0:15]
    ds_read_b64_tr_b16 v[120:121], v158 offset:12288
    ds_read_b64_tr_b16 v[122:123], v158 offset:12800
    v_mfma_f32_32x32x16_bf16 v[16:31], v[52:55], v[68:71], v[16:31]
    ds_read_b128 v[88:91], v162 offset:16384
    ds_read_b128 v[104:107], v162 offset:24576
    v_mfma_f32_32x32x16_bf16 v[0:15], v[40:43], v[72:75], v[0:15]
    ds_read_b64_tr_b16 v[124:125], v158 offset:14336
    ds_read_b64_tr_b16 v[126:127], v158 offset:14848
    v_mfma_f32_32x32x16_bf16 v[16:31], v[56:59], v[72:75], v[16:31]
    ds_read_b128 v[92:95], v163 offset:16384
    ds_read_b128 v[108:111], v163 offset:24576
    v_mfma_f32_32x32x16_bf16 v[0:15], v[44:47], v[76:79], v[0:15]
    v_mfma_f32_32x32x16_bf16 v[16:31], v[60:63], v[76:79], v[16:31]
    s_waitcnt lgkmcnt(0)
    s_barrier
    v_mfma_f32_32x32x16_bf16 v[0:15], v[80:83], v[112:115], v[0:15]
    ds_read_b64_tr_b16 v[64:65], v158 offset:16384
    ds_read_b64_tr_b16 v[66:67], v158 offset:16896
    ds_read_b128 v[32:35], v160 offset:32768
    ds_read_b128 v[48:51], v160 offset:40960
    v_mfma_f32_32x32x16_bf16 v[16:31], v[96:99], v[112:115], v[16:31]
    ds_read_b64_tr_b16 v[68:69], v158 offset:18432
    ds_read_b64_tr_b16 v[70:71], v158 offset:18944
    ds_read_b128 v[36:39], v161 offset:32768
    ds_read_b128 v[52:55], v161 offset:40960
    v_mfma_f32_32x32x16_bf16 v[0:15], v[84:87], v[116:119], v[0:15]
    ds_read_b64_tr_b16 v[72:73], v158 offset:20480
    ds_read_b64_tr_b16 v[74:75], v158 offset:20992
    v_mfma_f32_32x32x16_bf16 v[16:31], v[100:103], v[116:119], v[16:31]
    ds_read_b128 v[40:43], v162 offset:32768
    ds_read_b128 v[56:59], v162 offset:40960
    v_mfma_f32_32x32x16_bf16 v[0:15], v[88:91], v[120:123], v[0:15]
    ds_read_b64_tr_b16 v[76:77], v158 offset:22528
    ds_read_b64_tr_b16 v[78:79], v158 offset:23040
    v_mfma_f32_32x32x16_bf16 v[16:31], v[104:107], v[120:123], v[16:31]
    ds_read_b128 v[44:47], v163 offset:32768
    ds_read_b128 v[60:63], v163 offset:40960
    v_mfma_f32_32x32x16_bf16 v[0:15], v[92:95], v[124:127], v[0:15]
    v_mfma_f32_32x32x16_bf16 v[16:31], v[108:111], v[124:127], v[16:31]
    s_waitcnt lgkmcnt(0)
    s_barrier
    v_mfma_f32_32x32x16_bf16 v[0:15], v[32:35], v[64:67], v[0:15]
    ds_read_b64_tr_b16 v[112:113], v158 offset:0
    ds_read_b64_tr_b16 v[114:115], v158 offset:512
    ds_read_b128 v[80:83], v160 offset:49152
    ds_read_b128 v[96:99], v160 offset:57344
    v_mfma_f32_32x32x16_bf16 v[16:31], v[48:51], v[64:67], v[16:31]
    ds_read_b64_tr_b16 v[116:117], v158 offset:2048
    ds_read_b64_tr_b16 v[118:119], v158 offset:2560
    ds_read_b128 v[84:87], v161 offset:49152
    ds_read_b128 v[100:103], v161 offset:57344
    v_mfma_f32_32x32x16_bf16 v[0:15], v[36:39], v[68:71], v[0:15]
    ds_read_b64_tr_b16 v[120:121], v158 offset:4096
    ds_read_b64_tr_b16 v[122:123], v158 offset:4608
    v_mfma_f32_32x32x16_bf16 v[16:31], v[52:55], v[68:71], v[16:31]
    ds_read_b128 v[88:91], v162 offset:49152
    ds_read_b128 v[104:107], v162 offset:57344
    v_mfma_f32_32x32x16_bf16 v[0:15], v[40:43], v[72:75], v[0:15]
    ds_read_b64_tr_b16 v[124:125], v158 offset:6144
    ds_read_b64_tr_b16 v[126:127], v158 offset:6656
    v_mfma_f32_32x32x16_bf16 v[16:31], v[56:59], v[72:75], v[16:31]
    ds_read_b128 v[92:95], v163 offset:49152
    ds_read_b128 v[108:111], v163 offset:57344
    v_mfma_f32_32x32x16_bf16 v[0:15], v[44:47], v[76:79], v[0:15]
    v_mfma_f32_32x32x16_bf16 v[16:31], v[60:63], v[76:79], v[16:31]
    v_add_u32 v160, 0x10000, v160
    v_add_u32 v161, 0x10000, v161
    v_add_u32 v162, 0x10000, v162
    v_add_u32 v163, 0x10000, v163
    s_waitcnt lgkmcnt(0)
    s_barrier
    v_mfma_f32_32x32x16_bf16 v[0:15], v[80:83], v[112:115], v[0:15]
    ds_read_b64_tr_b16 v[64:65], v158 offset:8192
    ds_read_b64_tr_b16 v[66:67], v158 offset:8704
    ds_read_b128 v[32:35], v160 offset:0
    ds_read_b128 v[48:51], v160 offset:8192
    v_mfma_f32_32x32x16_bf16 v[16:31], v[96:99], v[112:115], v[16:31]
    ds_read_b64_tr_b16 v[68:69], v158 offset:10240
    ds_read_b64_tr_b16 v[70:71], v158 offset:10752
    ds_read_b128 v[36:39], v161 offset:0
    ds_read_b128 v[52:55], v161 offset:8192
    v_mfma_f32_32x32x16_bf16 v[0:15], v[84:87], v[116:119], v[0:15]
    ds_read_b64_tr_b16 v[72:73], v158 offset:12288
    ds_read_b64_tr_b16 v[74:75], v158 offset:12800
    v_mfma_f32_32x32x16_bf16 v[16:31], v[100:103], v[116:119], v[16:31]
    ds_read_b128 v[40:43], v162 offset:0
    ds_read_b128 v[56:59], v162 offset:8192
    v_mfma_f32_32x32x16_bf16 v[0:15], v[88:91], v[120:123], v[0:15]
    ds_read_b64_tr_b16 v[76:77], v158 offset:14336
    ds_read_b64_tr_b16 v[78:79], v158 offset:14848
    v_mfma_f32_32x32x16_bf16 v[16:31], v[104:107], v[120:123], v[16:31]
    ds_read_b128 v[44:47], v163 offset:0
    ds_read_b128 v[60:63], v163 offset:8192
    v_mfma_f32_32x32x16_bf16 v[0:15], v[92:95], v[124:127], v[0:15]
    v_mfma_f32_32x32x16_bf16 v[16:31], v[108:111], v[124:127], v[16:31]
    s_waitcnt lgkmcnt(0)
    s_barrier
    v_mfma_f32_32x32x16_bf16 v[0:15], v[32:35], v[64:67], v[0:15]
    ds_read_b64_tr_b16 v[112:113], v158 offset:16384
    ds_read_b64_tr_b16 v[114:115], v158 offset:16896
    ds_read_b128 v[80:83], v160 offset:16384
    ds_read_b128 v[96:99], v160 offset:24576
    v_mfma_f32_32x32x16_bf16 v[16:31], v[48:51], v[64:67], v[16:31]
    ds_read_b64_tr_b16 v[116:117], v158 offset:18432
    ds_read_b64_tr_b16 v[118:119], v158 offset:18944
    ds_read_b128 v[84:87], v161 offset:16384
    ds_read_b128 v[100:103], v161 offset:24576
    v_mfma_f32_32x32x16_bf16 v[0:15], v[36:39], v[68:71], v[0:15]
    ds_read_b64_tr_b16 v[120:121], v158 offset:20480
    ds_read_b64_tr_b16 v[122:123], v158 offset:20992
    v_mfma_f32_32x32x16_bf16 v[16:31], v[52:55], v[68:71], v[16:31]
    ds_read_b128 v[88:91], v162 offset:16384
    ds_read_b128 v[104:107], v162 offset:24576
    v_mfma_f32_32x32x16_bf16 v[0:15], v[40:43], v[72:75], v[0:15]
    ds_read_b64_tr_b16 v[124:125], v158 offset:22528
    ds_read_b64_tr_b16 v[126:127], v158 offset:23040
    v_mfma_f32_32x32x16_bf16 v[16:31], v[56:59], v[72:75], v[16:31]
    ds_read_b128 v[92:95], v163 offset:16384
    ds_read_b128 v[108:111], v163 offset:24576
    v_mfma_f32_32x32x16_bf16 v[0:15], v[44:47], v[76:79], v[0:15]
    v_mfma_f32_32x32x16_bf16 v[16:31], v[60:63], v[76:79], v[16:31]
    s_waitcnt lgkmcnt(0)
    s_barrier
    v_mfma_f32_32x32x16_bf16 v[0:15], v[80:83], v[112:115], v[0:15]
    ds_read_b64_tr_b16 v[64:65], v158 offset:0
    ds_read_b64_tr_b16 v[66:67], v158 offset:512
    ds_read_b128 v[32:35], v160 offset:32768
    ds_read_b128 v[48:51], v160 offset:40960
    v_mfma_f32_32x32x16_bf16 v[16:31], v[96:99], v[112:115], v[16:31]
    ds_read_b64_tr_b16 v[68:69], v158 offset:2048
    ds_read_b64_tr_b16 v[70:71], v158 offset:2560
    ds_read_b128 v[36:39], v161 offset:32768
    ds_read_b128 v[52:55], v161 offset:40960
    v_mfma_f32_32x32x16_bf16 v[0:15], v[84:87], v[116:119], v[0:15]
    ds_read_b64_tr_b16 v[72:73], v158 offset:4096
    ds_read_b64_tr_b16 v[74:75], v158 offset:4608
    v_mfma_f32_32x32x16_bf16 v[16:31], v[100:103], v[116:119], v[16:31]
    ds_read_b128 v[40:43], v162 offset:32768
    ds_read_b128 v[56:59], v162 offset:40960
    v_mfma_f32_32x32x16_bf16 v[0:15], v[88:91], v[120:123], v[0:15]
    ds_read_b64_tr_b16 v[76:77], v158 offset:6144
    ds_read_b64_tr_b16 v[78:79], v158 offset:6656
    v_mfma_f32_32x32x16_bf16 v[16:31], v[104:107], v[120:123], v[16:31]
    ds_read_b128 v[44:47], v163 offset:32768
    ds_read_b128 v[60:63], v163 offset:40960
    v_mfma_f32_32x32x16_bf16 v[0:15], v[92:95], v[124:127], v[0:15]
    v_mfma_f32_32x32x16_bf16 v[16:31], v[108:111], v[124:127], v[16:31]
    s_waitcnt lgkmcnt(0)
    v_mfma_f32_32x32x16_bf16 v[0:15], v[32:35], v[64:67], v[0:15]
    v_mfma_f32_32x32x16_bf16 v[16:31], v[48:51], v[64:67], v[16:31]
    v_mfma_f32_32x32x16_bf16 v[0:15], v[36:39], v[68:71], v[0:15]
    v_mfma_f32_32x32x16_bf16 v[16:31], v[52:55], v[68:71], v[16:31]
    v_mfma_f32_32x32x16_bf16 v[0:15], v[40:43], v[72:75], v[0:15]
    v_mfma_f32_32x32x16_bf16 v[16:31], v[56:59], v[72:75], v[16:31]
    v_mfma_f32_32x32x16_bf16 v[0:15], v[44:47], v[76:79], v[0:15]
    v_mfma_f32_32x32x16_bf16 v[16:31], v[60:63], v[76:79], v[16:31]
    s_barrier
    ds_read_b64_tr_b16 v[112:113], v158 offset:8192
    ds_read_b64_tr_b16 v[114:115], v158 offset:8704
    ds_read_b128 v[80:83], v160 offset:49152
    ds_read_b64_tr_b16 v[116:117], v158 offset:10240
    ds_read_b64_tr_b16 v[118:119], v158 offset:10752
    ds_read_b128 v[84:87], v161 offset:49152
    ds_read_b64_tr_b16 v[120:121], v158 offset:12288
    ds_read_b64_tr_b16 v[122:123], v158 offset:12800
    ds_read_b128 v[88:91], v162 offset:49152
    ds_read_b64_tr_b16 v[124:125], v158 offset:14336
    ds_read_b64_tr_b16 v[126:127], v158 offset:14848
    ds_read_b128 v[92:95], v163 offset:49152
    ds_read_b128 v[96:99], v160 offset:57344
    ds_read_b128 v[100:103], v161 offset:57344
    ds_read_b128 v[104:107], v162 offset:57344
    ds_read_b128 v[108:111], v163 offset:57344
    s_waitcnt lgkmcnt(13)
    v_mfma_f32_32x32x16_bf16 v[0:15], v[80:83], v[112:115], v[0:15]
    s_waitcnt lgkmcnt(10)
    v_mfma_f32_32x32x16_bf16 v[0:15], v[84:87], v[116:119], v[0:15]
    s_waitcnt lgkmcnt(7)
    v_mfma_f32_32x32x16_bf16 v[0:15], v[88:91], v[120:123], v[0:15]
    s_waitcnt lgkmcnt(4)
    v_mfma_f32_32x32x16_bf16 v[0:15], v[92:95], v[124:127], v[0:15]
    s_barrier
    s_waitcnt lgkmcnt(3)
    v_mfma_f32_32x32x16_bf16 v[16:31], v[96:99], v[112:115], v[16:31]
    s_waitcnt lgkmcnt(2)
    v_mfma_f32_32x32x16_bf16 v[16:31], v[100:103], v[116:119], v[16:31]
    s_waitcnt lgkmcnt(1)
    v_mfma_f32_32x32x16_bf16 v[16:31], v[104:107], v[120:123], v[16:31]
    s_waitcnt lgkmcnt(0)
    v_mfma_f32_32x32x16_bf16 v[16:31], v[108:111], v[124:127], v[16:31]
L_genE:
    s_nop 2
    v_cvt_pk_bf16_f32 v0, v0, v1
    v_cvt_pk_bf16_f32 v1, v2, v3
    v_cvt_pk_bf16_f32 v2, v4, v5
    v_cvt_pk_bf16_f32 v3, v6, v7
    v_cvt_pk_bf16_f32 v4, v8, v9
    v_cvt_pk_bf16_f32 v5, v10, v11
    v_cvt_pk_bf16_f32 v6, v12, v13
    v_cvt_pk_bf16_f32 v7, v14, v15
    buffer_store_dwordx4 v[0:3], v157, s[48:51], s66 offen sc1
    buffer_store_dwordx4 v[4:7], v157, s[48:51], s67 offen sc1
    v_cvt_pk_bf16_f32 v16, v16, v17
    v_cvt_pk_bf16_f32 v17, v18, v19
    v_cvt_pk_bf16_f32 v18, v20, v21
    v_cvt_pk_bf16_f32 v19, v22, v23
    v_cvt_pk_bf16_f32 v20, v24, v25
    v_cvt_pk_bf16_f32 v21, v26, v27
    v_cvt_pk_bf16_f32 v22, v28, v29
    v_cvt_pk_bf16_f32 v23, v30, v31
    buffer_store_dwordx4 v[16:19], v157, s[48:51], s66 offen offset:2048 sc1
    buffer_store_dwordx4 v[20:23], v157, s[48:51], s67 offen offset:2048 sc1
    v_and_b32 v166, 3, v159
    v_lshlrev_b32 v166, 2, v166
    v_add_u32 v166, 162816, v166
    s_lshl_b32 s11, s3, 2
    s_add_u32 s11, s11, 162816
    v_mov_b32 v165, s11
    v_lshlrev_b32 v146, 15, v159
    s_lshl_b32 s65, s7, 4
    s_add_u32 s65, s65, s6
    s_lshl_b32 s65, s65, 7
    s_lshl_b32 s64, s15, 2
    s_add_u32 s64, s64, s65
    s_add_u32 s64, s64, 0x680000
    s_add_u32 s65, s65, 0x600000
    s_branch L_att
L_h2:
    s_lshr_b32 s13, s2, 3
    s_lshl_b32 s61, s7, 6
    s_add_u32 s79, s61, s63
    s_lshl_b32 s65, s3, 10
    s_add_u32 s65, s65, 0x20000
    s_add_u32 s66, s7, 1
    s_and_b32 s66, s66, 15
    s_lshl_b32 s66, s66, 10
    s_add_u32 s66, s66, 0x4000
    s_add_u32 s11, s65, 0x7000
    s_cmp_eq_u32 s3, 3
    s_cselect_b32 s66, s66, s11
    v_lshrrev_b32 v7, 2, v159
    v_and_b32 v3, 3, v159
    v_lshlrev_b32 v8, 4, v3
    v_mad_u32_u24 v14, v7, v6, v8
    s_mul_i32 s12, s14, 0x30000
    s_add_u32 s12, s12, s79
    s_add_u32 m0, s65, 0x6000
    s_add_u32 s14, s14, 1
    s_and_b32 s14, s14, 7
    buffer_load_dwordx4 v14, s[44:47], s12 offen lds
    s_mul_i32 s12, s14, 0x30000
    s_add_u32 s12, s12, s79
    s_mov_b32 m0, s66
    s_add_u32 s14, s14, 1
    s_and_b32 s14, s14, 7
    buffer_load_dwordx4 v14, s[44:47], s12 offen lds
    v_lshrrev_b32 v2, 3, v159
    v_add_u32 v4, s8, v2
    v_and_b32 v4, 7, v4
    v_and_b32 v5, 7, v159
    v_lshlrev_b32 v9, 4, v5
    v_lshl_add_u32 v87, v4, 7, v9
    s_lshl_b32 s11, s7, 2
    s_add_u32 s11, s11, s15
    s_and_b32 s12, s11, 7
    v_xor_b32 v5, s12, v5
    v_lshlrev_b32 v5, 4, v5
    v_lshl_add_u32 v5, v2, 14, v5
    s_lshl_b32 s12, s11, 8
    v_add_u32 v88, s12, v5
    s_lshl_b32 s12, s6, 6
    s_add_u32 s89, s11, s12
    v_and_b32 v166, 3, v159
    v_lshlrev_b32 v166, 2, v166
    v_add_u32 v166, 162816, v166
    s_lshl_b32 s11, s3, 2
    s_add_u32 s11, s11, 162816
    v_mov_b32 v165, s11
    s_waitcnt vmcnt(8)
    s_barrier
    s_mul_i32 s12, s14, 0x30000
    s_add_u32 s12, s12, s79
    s_add_u32 m0, s65, 0x4000
    s_add_u32 s14, s14, 1
    s_and_b32 s14, s14, 7
    buffer_load_dwordx4 v14, s[44:47], s12 offen lds
    s_mul_i32 s12, s14, 0x30000
    s_add_u32 s12, s12, s79
    s_add_u32 m0, s65, 0x5000
    s_add_u32 s14, s14, 1
    s_and_b32 s14, s14, 7
    buffer_load_dwordx4 v14, s[44:47], s12 offen lds
    s_waitcnt vmcnt(4)
    s_barrier
    s_mul_i32 s12, s14, 0x30000
    s_add_u32 s12, s12, s79
    s_add_u32 m0, s65, 0x0
    s_add_u32 s14, s14, 1
    s_and_b32 s14, s14, 7
    buffer_load_dwordx4 v14, s[44:47], s12 offen lds
    s_mul_i32 s12, s14, 0x30000
    s_add_u32 s12, s12, s79
    s_add_u32 m0, s65, 0x1000
    s_add_u32 s14, s14, 1
    s_and_b32 s14, s14, 7
    buffer_load_dwordx4 v14, s[44:47], s12 offen lds
    ds_read_b128 v[100:103], v88
    ds_read_b128 v[104:107], v88 offset:128
    s_waitcnt vmcnt(4) lgkmcnt(0)
    s_barrier
    s_mul_i32 s12, s14, 0x30000
    s_add_u32 s12, s12, s79
    s_add_u32 m0, s65, 0x2000
    s_add_u32 s14, s14, 1
    s_and_b32 s14, s14, 7
    buffer_load_dwordx4 v14, s[44:47], s12 offen lds
    s_mul_i32 s12, s14, 0x30000
    s_add_u32 s12, s12, s79
    s_add_u32 m0, s65, 0x3000
    s_add_u32 s14, s14, 1
    s_and_b32 s14, s14, 7
    buffer_load_dwordx4 v14, s[44:47], s12 offen lds
    s_mov_b64 s[48:49], s[38:39]
    s_mov_b32 s50, 0xa00000
    s_mov_b32 s51, 0x20000
    s_mov_b64 s[52:53], s[24:25]
    s_mov_b32 s54, 0x400
    s_mov_b32 s55, 0x20000
    s_mov_b64 s[56:57], s[32:33]
    s_mov_b32 s58, 0x400
    s_mov_b32 s59, 0x20000
    buffer_load_dwordx4 v[92:95], v87, s[52:55], 0 offen
    buffer_load_dwordx4 v[96:99], v87, s[56:59], 0 offen
    s_and_b32 s11, s2, 7
    s_lshl_b32 s11, s11, 15
    s_lshl_b32 s12, s13, 10
    s_add_u32 s11, s11, s12
    s_lshl_b32 s12, s3, 8
    s_add_u32 s11, s11, s12
    s_add_u32 s11, s11, 0x600000
    v_lshl_add_u32 v22, v159, 7, s11
    s_lshl_b32 s11, s7, 4
    s_add_u32 s11, s11, s6
    s_lshl_b32 s11, s11, 7
    s_add_u32 s11, s11, 0x680000
    v_writelane_b32 v22, s11, 2
    s_mov_b64 exec, 7
    buffer_load_dword v23, v22, s[48:51], 0 offen sc1
    s_mov_b64 exec, -1
    s_nop 0
    s_waitcnt vmcnt(7)
    v_mov_b32 v24, 1
    s_mov_b64 exec, 1
    ds_write_b32 v165, v24 offset:0
    s_mov_b64 exec, -1
    s_waitcnt vmcnt(5)
    v_mov_b32 v24, 2
    s_mov_b64 exec, 1
    ds_write_b32 v165, v24 offset:0
    s_mov_b64 exec, -1
    s_waitcnt vmcnt(3)
    v_mov_b32 v24, 3
    s_mov_b64 exec, 1
    ds_write_b32 v165, v24 offset:0
    s_mov_b64 exec, -1
    v_lshlrev_b32 v163, 4, v159
    v_lshl_add_u32 v15, v7, 10, v8
    v_bfe_u32 v2, v159, 2, 2
    v_lshrrev_b32 v147, 5, v159
    v_bfe_u32 v4, v159, 4, 1
    v_lshlrev_b32 v4, 5, v4
    v_lshl_add_u32 v5, v147, 2, v2
    v_lshl_add_u32 v149, v5, 6, v4
    v_and_b32 v5, 1, v159
    v_lshl_add_u32 v149, v5, 4, v149
    v_bfe_u32 v5, v159, 1, 1
    v_lshl_add_u32 v149, v5, 3, v149
    v_add_u32 v149, 90112, v149
    v_lshl_add_u32 v156, v147, 3, v2
    v_lshl_add_u32 v157, v3, 3, v4
    v_and_b32 v146, 31, v159
    v_lshlrev_b32 v150, 4, v147
    v_lshl_add_u32 v150, v146, 10, v150
    v_lshlrev_b32 v153, 3, v159
    s_lshl_b32 s92, s68, 15
    s_add_u32 s93, s92, 0x400000
    s_lshl_b32 s10, s7, 6
    s_add_u32 s92, s92, s10
    s_lshl_b32 s10, s68, 12
    s_add_u32 s94, s10, 0x640000
    v_lshlrev_b32 v151, 7, v159
    s_lshl_b32 s10, s68, 9
    s_add_u32 s10, s10, 0x820008
    v_lshrrev_b32 v154, 3, v146
    v_lshl_add_u32 v154, v154, 7, s10
    v_bfe_u32 v5, v159, 1, 2
    v_lshl_add_u32 v154, v5, 4, v154
    s_and_b32 s10, s2, 7
    s_lshl_b32 s10, s10, 7
    s_add_u32 s10, s10, 0x834000
    v_mov_b32 v155, s10
    s_nop 0
    s_mov_b32 s76, 0
lw_1:
    ds_read_b32 v164, v166 offset:48
    s_add_u32 s76, s76, 1
    s_waitcnt lgkmcnt(0)
    v_cmp_gt_u32 vcc, 1, v164
    s_cbranch_vccz lwd_2
    s_sleep 1
    s_cmp_lt_u32 s76, 0x40000
    s_cbranch_scc1 lw_1
lwd_2:
    v_readfirstlane_b32 s9, v164
    v_mov_b32 v112, 0
    v_mov_b32 v113, 0
    v_mov_b32 v114, 0
    v_mov_b32 v115, 0
    s_waitcnt vmcnt(0)
    v_dot2_f32_bf16 v112, v100, v92, v112
    v_dot2_f32_bf16 v113, v100, v96, v113
    v_dot2_f32_bf16 v114, v104, v92, v114
    v_dot2_f32_bf16 v115, v104, v96, v115
    v_dot2_f32_bf16 v112, v101, v93, v112
    v_dot2_f32_bf16 v113, v101, v97, v113
    v_dot2_f32_bf16 v114, v105, v93, v114
    v_dot2_f32_bf16 v115, v105, v97, v115
    v_dot2_f32_bf16 v112, v102, v94, v112
    v_dot2_f32_bf16 v113, v102, v98, v113
    v_dot2_f32_bf16 v114, v106, v94, v114
    v_dot2_f32_bf16 v115, v106, v98, v115
    v_dot2_f32_bf16 v112, v103, v95, v112
    v_dot2_f32_bf16 v113, v103, v99, v113
    v_dot2_f32_bf16 v114, v107, v95, v114
    v_dot2_f32_bf16 v115, v107, v99, v115
    s_nop 2
    v_add_f32_dpp v112, v112, v112 quad_perm:[1,0,3,2] row_mask:0xf bank_mask:0xf
    v_add_f32_dpp v113, v113, v113 quad_perm:[1,0,3,2] row_mask:0xf bank_mask:0xf
    v_add_f32_dpp v114, v114, v114 quad_perm:[1,0,3,2] row_mask:0xf bank_mask:0xf
    v_add_f32_dpp v115, v115, v115 quad_perm:[1,0,3,2] row_mask:0xf bank_mask:0xf
    v_add_f32_dpp v112, v112, v112 quad_perm:[2,3,0,1] row_mask:0xf bank_mask:0xf
    v_add_f32_dpp v113, v113, v113 quad_perm:[2,3,0,1] row_mask:0xf bank_mask:0xf
    v_add_f32_dpp v114, v114, v114 quad_perm:[2,3,0,1] row_mask:0xf bank_mask:0xf
    v_add_f32_dpp v115, v115, v115 quad_perm:[2,3,0,1] row_mask:0xf bank_mask:0xf
    v_add_f32_dpp v112, v112, v112 row_half_mirror row_mask:0xf bank_mask:0xf
    v_add_f32_dpp v113, v113, v113 row_half_mirror row_mask:0xf bank_mask:0xf
    v_add_f32_dpp v114, v114, v114 row_half_mirror row_mask:0xf bank_mask:0xf
    v_add_f32_dpp v115, v115, v115 row_half_mirror row_mask:0xf bank_mask:0xf
    v_add_f32_dpp v112, v112, v112 row_mirror row_mask:0xf bank_mask:0xf
    v_add_f32_dpp v113, v113, v113 row_mirror row_mask:0xf bank_mask:0xf
    v_add_f32_dpp v114, v114, v114 row_mirror row_mask:0xf bank_mask:0xf
    v_add_f32_dpp v115, v115, v115 row_mirror row_mask:0xf bank_mask:0xf
    v_add_f32_dpp v112, v112, v112 row_bcast:15 row_mask:0xa bank_mask:0xf
    v_add_f32_dpp v113, v113, v113 row_bcast:15 row_mask:0xa bank_mask:0xf
    v_add_f32_dpp v114, v114, v114 row_bcast:15 row_mask:0xa bank_mask:0xf
    v_add_f32_dpp v115, v115, v115 row_bcast:15 row_mask:0xa bank_mask:0xf
    v_add_f32_dpp v112, v112, v112 row_bcast:31 row_mask:0xc bank_mask:0xf
    v_add_f32_dpp v113, v113, v113 row_bcast:31 row_mask:0xc bank_mask:0xf
    v_add_f32_dpp v114, v114, v114 row_bcast:31 row_mask:0xc bank_mask:0xf
    v_add_f32_dpp v115, v115, v115 row_bcast:31 row_mask:0xc bank_mask:0xf
    v_cvt_pk_bf16_f32 v100, v112, v114
    v_cvt_pk_bf16_f32 v101, v113, v115
    s_mov_b32 s11, 0x3fb8aa3b
    v_lshlrev_b32 v38, 16, v101
    v_and_b32 v39, 0xffff0000, v101
    v_mul_f32 v38, s11, v38
    v_mul_f32 v39, s11, v39
    v_exp_f32 v38, -v38
    v_exp_f32 v39, -v39
    v_lshlrev_b32 v40, 16, v100
    v_and_b32 v41, 0xffff0000, v100
    v_add_f32 v38, 1.0, v38
    v_add_f32 v39, 1.0, v39
    v_rcp_f32 v38, v38
    v_rcp_f32 v39, v39
    v_ashrrev_i32 v42, 31, v40
    v_ashrrev_i32 v43, 31, v41
    v_cvt_pk_bf16_f32 v118, v38, v39
    v_or_b32 v42, 0x80000000, v42
    v_or_b32 v43, 0x80000000, v43
    v_xor_b32 v40, v40, v42
    v_xor_b32 v41, v41, v43
    v_and_b32 v40, 0xffff0000, v40
    v_and_b32 v41, 0xffff0000, v41
    s_lshl_b32 s12, s89, 1
    s_sub_u32 s12, 2047, s12
    s_sub_u32 s13, s12, 1
    v_or_b32 v40, s12, v40
    v_or_b32 v41, s13, v41
    v_max_u32 v116, v40, v41
    v_mov_b32 v117, s9
    v_mov_b32 v119, s9
    s_lshl_b32 s11, s3, 4
    s_add_u32 s11, s11, 163328
    v_mov_b32 v120, s11
    s_mov_b32 exec_lo, 0
    s_mov_b32 exec_hi, 0x80000000
    ds_write_b128 v120, v[116:119]
    s_mov_b64 exec, -1
    s_waitcnt lgkmcnt(0)
    v_mov_b32 v24, 4
    s_mov_b64 exec, 1
    ds_write_b32 v165, v24 offset:0
    s_mov_b64 exec, -1
    s_cmp_lg_u32 s3, 3
    s_cbranch_scc1 L_h012
    s_and_b32 s11, s2, 7
    s_lshl_b32 s11, s11, 15
    s_lshl_b32 s12, s4, 12
    s_add_u32 s11, s11, s12
    s_add_u32 s11, s11, 0x600000
    v_lshl_add_u32 v2, v159, 7, s11
    s_mov_b32 s76, 0
lw_3:
    ds_read_b32 v164, v166 offset:16
    s_add_u32 s76, s76, 1
    s_waitcnt lgkmcnt(0)
    v_cmp_gt_u32 vcc, 10, v164
    s_cbranch_vccz lwd_4
    s_sleep 1
    s_cmp_lt_u32 s76, 0x40000
    s_cbranch_scc1 lw_3
lwd_4:
    s_mov_b32 s76, 0
lw_5:
    ds_read_b32 v164, v166 offset:32
    s_add_u32 s76, s76, 1
    s_waitcnt lgkmcnt(0)
    v_cmp_gt_u32 vcc, 10, v164
    s_cbranch_vccz lwd_6
    s_sleep 1
    s_cmp_lt_u32 s76, 0x40000
    s_cbranch_scc1 lw_5
lwd_6:
    s_mov_b32 exec_hi, 0
    s_mov_b32 s76, 0
poll_7:
    buffer_load_dword v3, v2, s[48:51], 0 offen sc1
    s_add_u32 s76, s76, 1
    s_waitcnt vmcnt(0)
    v_cmp_ne_u32 vcc, s9, v3
    s_cbranch_vccz polldone_8
    s_sleep 1
    s_cmp_lt_u32 s76, 40000
    s_cbranch_scc1 poll_7
polldone_8:
    s_mov_b64 exec, -1
    v_mov_b32 v2, 1
    s_mov_b64 exec, 15
    ds_write_b32 v166, v2 offset:80
    s_mov_b64 exec, -1
    s_mov_b64 exec, 15
    ds_write_b32 v166, v2 offset:96
    s_mov_b64 exec, -1
    s_branch L_h012
L_R:
    s_barrier
    s_waitcnt lgkmcnt(0)
    s_barrier
    ds_read_b64_tr_b16 v[32:33], v84 offset:24576
    ds_read_b64_tr_b16 v[34:35], v84 offset:24832
    ds_read_b64_tr_b16 v[36:37], v84 offset:25600
    ds_read_b64_tr_b16 v[38:39], v84 offset:25856
    ds_read_b64_tr_b16 v[40:41], v84 offset:26624
    ds_read_b64_tr_b16 v[42:43], v84 offset:26880
    ds_read_b64_tr_b16 v[44:45], v84 offset:27648
    ds_read_b64_tr_b16 v[46:47], v84 offset:27904
    s_cmp_lg_u32 s3, 11
    s_cbranch_scc1 n11_38
    s_mov_b32 s76, 0
L_xid:
    s_waitcnt vmcnt(0)
    v_cmp_ne_u32 vcc, s9, v109
    s_cbranch_vccz L_xidok
    buffer_load_dwordx2 v[108:109], v89, s[48:51], 0 offen sc1
    s_add_u32 s76, s76, 1
    s_cmp_lt_u32 s76, 40000
    s_cbranch_scc1 L_xid
    s_waitcnt vmcnt(0)
L_xidok:
    v_cmp_ne_u32 s[10:11], s93, v108
    s_or_b64 vcc, vcc, s[10:11]
    s_cmp_eq_u64 vcc, 0
    s_cselect_b32 s10, 1, 2
    v_mov_b32 v108, s10
    s_mov_b64 exec, 15
    ds_write_b32 v166, v108 offset:64
    s_mov_b64 exec, -1
n11_38:
    s_waitcnt lgkmcnt(6)
    v_mfma_f32_32x32x16_bf16 v[0:15], v[32:35], v[16:19], 0
    ds_read_b32 v164, v166 offset:0
    ds_read_b64_tr_b16 v[64:65], v84 offset:28672
    ds_read_b64_tr_b16 v[66:67], v84 offset:28928
    s_waitcnt lgkmcnt(7)
    v_mfma_f32_32x32x16_bf16 v[0:15], v[36:39], v[20:23], v[0:15]
    ds_read_b64_tr_b16 v[68:69], v84 offset:29696
    ds_read_b64_tr_b16 v[70:71], v84 offset:29952
    s_waitcnt lgkmcnt(7)
    v_mfma_f32_32x32x16_bf16 v[0:15], v[40:43], v[24:27], v[0:15]
    ds_read_b64_tr_b16 v[72:73], v84 offset:30720
    ds_read_b64_tr_b16 v[74:75], v84 offset:30976
    s_waitcnt lgkmcnt(7)
    v_mfma_f32_32x32x16_bf16 v[0:15], v[44:47], v[28:31], v[0:15]
    ds_read_b64_tr_b16 v[76:77], v85 offset:0
    ds_read_b64_tr_b16 v[78:79], v85 offset:256
    s_waitcnt lgkmcnt(6)
    v_mfma_f32_32x32x16_bf16 v[0:15], v[64:67], v[48:51], v[0:15]
    v_cmp_gt_u32 vcc, 1, v164
    s_cbranch_vccz st_39
    s_mov_b32 s76, 0
lw_40:
    ds_read_b32 v164, v166 offset:0
    s_add_u32 s76, s76, 1
    s_waitcnt lgkmcnt(0)
    v_cmp_gt_u32 vcc, 1, v164
    s_cbranch_vccz lwd_41
    s_cmp_lt_u32 s76, 0x40000
    s_cbranch_scc1 lw_40
lwd_41:
st_39:
    ds_read_b128 v[16:19], v80 offset:32768
    ds_read_b64_tr_b16 v[32:33], v84 offset:16384
    ds_read_b64_tr_b16 v[34:35], v84 offset:16640
    s_waitcnt lgkmcnt(7)
    v_mfma_f32_32x32x16_bf16 v[0:15], v[68:71], v[52:55], v[0:15]
    ds_read_b128 v[20:23], v81 offset:32768
    ds_read_b64_tr_b16 v[36:37], v84 offset:17408
    ds_read_b64_tr_b16 v[38:39], v84 offset:17664
    s_waitcnt lgkmcnt(8)
    v_mfma_f32_32x32x16_bf16 v[0:15], v[72:75], v[56:59], v[0:15]
    ds_read_b128 v[24:27], v82 offset:32768
    ds_read_b64_tr_b16 v[40:41], v84 offset:18432
    ds_read_b64_tr_b16 v[42:43], v84 offset:18688
    s_waitcnt lgkmcnt(9)
    v_mfma_f32_32x32x16_bf16 v[0:15], v[76:79], v[60:63], v[0:15]
    ds_read_b128 v[28:31], v83 offset:32768
    ds_read_b64_tr_b16 v[44:45], v84 offset:19456
    ds_read_b64_tr_b16 v[46:47], v84 offset:19712
    s_waitcnt lgkmcnt(9)
    v_mfma_f32_32x32x16_bf16 v[0:15], v[32:35], v[16:19], v[0:15]
    ds_read_b32 v164, v166 offset:0
    ds_read_b128 v[48:51], v80 offset:49152
    ds_read_b64_tr_b16 v[64:65], v84 offset:20480
    ds_read_b64_tr_b16 v[66:67], v84 offset:20736
    s_waitcnt lgkmcnt(10)
    v_mfma_f32_32x32x16_bf16 v[0:15], v[36:39], v[20:23], v[0:15]
    ds_read_b128 v[52:55], v81 offset:49152
    ds_read_b64_tr_b16 v[68:69], v84 offset:21504
    ds_read_b64_tr_b16 v[70:71], v84 offset:21760
    s_waitcnt lgkmcnt(10)
    v_mfma_f32_32x32x16_bf16 v[0:15], v[40:43], v[24:27], v[0:15]
    ds_read_b128 v[56:59], v82 offset:49152
    ds_read_b64_tr_b16 v[72:73], v84 offset:22528
    ds_read_b64_tr_b16 v[74:75], v84 offset:22784
    s_waitcnt lgkmcnt(10)
    v_mfma_f32_32x32x16_bf16 v[0:15], v[44:47], v[28:31], v[0:15]
    ds_read_b128 v[60:63], v83 offset:49152
    ds_read_b64_tr_b16 v[76:77], v84 offset:23552
    ds_read_b64_tr_b16 v[78:79], v84 offset:23808
    s_waitcnt lgkmcnt(9)
    v_mfma_f32_32x32x16_bf16 v[0:15], v[64:67], v[48:51], v[0:15]
    v_cmp_gt_u32 vcc, 2, v164
    s_cbranch_vccz st_42
    s_mov_b32 s76, 0
lw_43:
    ds_read_b32 v164, v166 offset:0
    s_add_u32 s76, s76, 1
    s_waitcnt lgkmcnt(0)
    v_cmp_gt_u32 vcc, 2, v164
    s_cbranch_vccz lwd_44
    s_cmp_lt_u32 s76, 0x40000
    s_cbranch_scc1 lw_43
lwd_44:
st_42:
    v_add_u32 v80, 0x10000, v80
    ds_read_b128 v[16:19], v80 offset:0
    ds_read_b64_tr_b16 v[32:33], v84 offset:0
    ds_read_b64_tr_b16 v[34:35], v84 offset:256
    s_waitcnt lgkmcnt(9)
    v_mfma_f32_32x32x16_bf16 v[0:15], v[68:71], v[52:55], v[0:15]
    v_add_u32 v81, 0x10000, v81
    ds_read_b128 v[20:23], v81 offset:0
    ds_read_b64_tr_b16 v[36:37], v84 offset:1024
    ds_read_b64_tr_b16 v[38:39], v84 offset:1280
    s_waitcnt lgkmcnt(9)
    v_mfma_f32_32x32x16_bf16 v[0:15], v[72:75], v[56:59], v[0:15]
    v_add_u32 v82, 0x10000, v82
    ds_read_b128 v[24:27], v82 offset:0
    ds_read_b64_tr_b16 v[40:41], v84 offset:2048
    ds_read_b64_tr_b16 v[42:43], v84 offset:2304
    s_waitcnt lgkmcnt(9)
    v_mfma_f32_32x32x16_bf16 v[0:15], v[76:79], v[60:63], v[0:15]
    v_add_u32 v83, 0x10000, v83
    ds_read_b128 v[28:31], v83 offset:0
    ds_read_b64_tr_b16 v[44:45], v84 offset:3072
    ds_read_b64_tr_b16 v[46:47], v84 offset:3328
    s_waitcnt lgkmcnt(9)
    v_mfma_f32_32x32x16_bf16 v[0:15], v[32:35], v[16:19], v[0:15]
    ds_read_b32 v164, v166 offset:0
    ds_read_b128 v[48:51], v80 offset:16384
    ds_read_b64_tr_b16 v[64:65], v84 offset:4096
    ds_read_b64_tr_b16 v[66:67], v84 offset:4352
    s_waitcnt lgkmcnt(10)
    v_mfma_f32_32x32x16_bf16 v[0:15], v[36:39], v[20:23], v[0:15]
    ds_read_b128 v[52:55], v81 offset:16384
    ds_read_b64_tr_b16 v[68:69], v84 offset:5120
    ds_read_b64_tr_b16 v[70:71], v84 offset:5376
    s_waitcnt lgkmcnt(10)
    v_mfma_f32_32x32x16_bf16 v[0:15], v[40:43], v[24:27], v[0:15]
    ds_read_b128 v[56:59], v82 offset:16384
    ds_read_b64_tr_b16 v[72:73], v84 offset:6144
    ds_read_b64_tr_b16 v[74:75], v84 offset:6400
    s_waitcnt lgkmcnt(10)
    v_mfma_f32_32x32x16_bf16 v[0:15], v[44:47], v[28:31], v[0:15]
    ds_read_b128 v[60:63], v83 offset:16384
    ds_read_b64_tr_b16 v[76:77], v84 offset:7168
    ds_read_b64_tr_b16 v[78:79], v84 offset:7424
    s_waitcnt lgkmcnt(9)
    v_mfma_f32_32x32x16_bf16 v[0:15], v[64:67], v[48:51], v[0:15]
    v_cmp_gt_u32 vcc, 3, v164
    s_cbranch_vccz st_45
    s_mov_b32 s76, 0
lw_46:
    ds_read_b32 v164, v166 offset:0
    s_add_u32 s76, s76, 1
    s_waitcnt lgkmcnt(0)
    v_cmp_gt_u32 vcc, 3, v164
    s_cbranch_vccz lwd_47
    s_cmp_lt_u32 s76, 0x40000
    s_cbranch_scc1 lw_46
lwd_47:
st_45:
    ds_read_b128 v[16:19], v80 offset:32768
    ds_read_b64_tr_b16 v[32:33], v84 offset:8192
    ds_read_b64_tr_b16 v[34:35], v84 offset:8448
    s_waitcnt lgkmcnt(9)
    v_mfma_f32_32x32x16_bf16 v[0:15], v[68:71], v[52:55], v[0:15]
    ds_read_b128 v[20:23], v81 offset:32768
    ds_read_b64_tr_b16 v[36:37], v84 offset:9216
    ds_read_b64_tr_b16 v[38:39], v84 offset:9472
    s_waitcnt lgkmcnt(9)
    v_mfma_f32_32x32x16_bf16 v[0:15], v[72:75], v[56:59], v[0:15]
    ds_read_b128 v[24:27], v82 offset:32768
    ds_read_b64_tr_b16 v[40:41], v84 offset:10240
    ds_read_b64_tr_b16 v[42:43], v84 offset:10496
    s_waitcnt lgkmcnt(9)
    v_mfma_f32_32x32x16_bf16 v[0:15], v[76:79], v[60:63], v[0:15]
    ds_read_b128 v[28:31], v83 offset:32768
    ds_read_b64_tr_b16 v[44:45], v84 offset:11264
    ds_read_b64_tr_b16 v[46:47], v84 offset:11520
    s_waitcnt lgkmcnt(9)
    v_mfma_f32_32x32x16_bf16 v[0:15], v[32:35], v[16:19], v[0:15]
    ds_read_b128 v[48:51], v80 offset:49152
    ds_read_b64_tr_b16 v[64:65], v84 offset:12288
    ds_read_b64_tr_b16 v[66:67], v84 offset:12544
    s_waitcnt lgkmcnt(9)
    v_mfma_f32_32x32x16_bf16 v[0:15], v[36:39], v[20:23], v[0:15]
    ds_read_b128 v[52:55], v81 offset:49152
    ds_read_b64_tr_b16 v[68:69], v84 offset:13312
    ds_read_b64_tr_b16 v[70:71], v84 offset:13568
    s_waitcnt lgkmcnt(9)
    v_mfma_f32_32x32x16_bf16 v[0:15], v[40:43], v[24:27], v[0:15]
    ds_read_b128 v[56:59], v82 offset:49152
    ds_read_b64_tr_b16 v[72:73], v84 offset:14336
    ds_read_b64_tr_b16 v[74:75], v84 offset:14592
    s_waitcnt lgkmcnt(9)
    v_mfma_f32_32x32x16_bf16 v[0:15], v[44:47], v[28:31], v[0:15]
    ds_read_b128 v[60:63], v83 offset:49152
    ds_read_b64_tr_b16 v[76:77], v84 offset:15360
    ds_read_b64_tr_b16 v[78:79], v84 offset:15616
    s_waitcnt lgkmcnt(9)
    v_mfma_f32_32x32x16_bf16 v[0:15], v[64:67], v[48:51], v[0:15]
    s_waitcnt lgkmcnt(6)
    v_mfma_f32_32x32x16_bf16 v[0:15], v[68:71], v[52:55], v[0:15]
    s_waitcnt lgkmcnt(3)
    v_mfma_f32_32x32x16_bf16 v[0:15], v[72:75], v[56:59], v[0:15]
    s_waitcnt lgkmcnt(0)
    v_mfma_f32_32x32x16_bf16 v[0:15], v[76:79], v[60:63], v[0:15]
    ds_read_b32 v111, v166 offset:48
    s_mov_b32 s10, 0x3eb8aa3b
    s_mov_b32 s11, s10
    s_nop 8
    v_pk_mul_f32 v[0:1], v[0:1], s[10:11]
    v_pk_mul_f32 v[2:3], v[2:3], s[10:11]
    v_pk_mul_f32 v[4:5], v[4:5], s[10:11]
    v_pk_mul_f32 v[6:7], v[6:7], s[10:11]
    v_pk_mul_f32 v[8:9], v[8:9], s[10:11]
    v_pk_mul_f32 v[10:11], v[10:11], s[10:11]
    v_pk_mul_f32 v[12:13], v[12:13], s[10:11]
    v_pk_mul_f32 v[14:15], v[14:15], s[10:11]
    v_cvt_pk_bf16_f32 v16, v0, v1
    v_cvt_pk_bf16_f32 v17, v2, v3
    v_cvt_pk_bf16_f32 v18, v4, v5
    v_cvt_pk_bf16_f32 v19, v6, v7
    v_cvt_pk_bf16_f32 v20, v8, v9
    v_cvt_pk_bf16_f32 v21, v10, v11
    v_cvt_pk_bf16_f32 v22, v12, v13
    v_cvt_pk_bf16_f32 v23, v14, v15
    ds_write_b128 v86, v[16:19]
    ds_write_b128 v86, v[20:23] offset:1024
    s_waitcnt lgkmcnt(0)
    v_mov_b32 v147, 3
    s_mov_b64 exec, 1
    ds_write_b32 v165, v147 offset:0
    s_mov_b64 exec, -1
    v_readfirstlane_b32 s9, v111
L_att:
    s_lshr_b32 s14, s3, 3
    s_lshl_b32 s10, s7, 1
    s_add_u32 s10, s10, s14
    s_lshl_b32 s10, s10, 17
    s_add_u32 s56, s38, s10
    s_addc_u32 s57, s39, 0
    s_mov_b32 s58, 0x20000
    s_mov_b32 s59, 0x20000
    s_mov_b32 s70, 0xffff
    s_mov_b32 s71, 0xffff
    s_and_b32 s10, s6, 14
    s_lshl_b32 s11, s10, 1
    s_add_u32 s11, s11, s15
    s_lshl_b32 s72, s11, 12
    v_lshlrev_b32 v163, 4, v159
    s_add_u32 s10, s10, s68
    s_lshl_b32 s12, s4, 5
    s_add_u32 s10, s10, s12
    s_lshl_b32 s10, s10, 7
    s_lshl_b32 s12, s5, 1
    s_add_u32 s12, s12, s69
    s_lshl_b32 s12, s12, 2
    s_add_u32 s10, s10, s12
    s_add_u32 s92, s10, 0x680000
    s_lshl_b32 s10, s15, 2
    s_add_u32 s10, s10, 162816
    v_mov_b32 v160, s10
    v_lshlrev_b32 v12, 11, v159
    v_lshrrev_b32 v8, 5, v159
    v_and_b32 v9, 15, v159
    v_lshlrev_b32 v9, 4, v9
    v_lshl_add_u32 v162, v8, 8, v9
    v_and_b32 v8, 31, v159
    v_cmp_eq_u32 vcc, 16, v8
    v_mov_b32 v8, 0x3f803f80
    v_mov_b32 v161, 0xdddddddd
    s_lshl_b32 s10, s14, 10
    v_cndmask_b32 v8, 0, v8, vcc
    v_add_u32 v11, s10, v163
    v_mov_b32 v9, v8
    v_mov_b64 v[116:117], v[8:9]
    v_mov_b64 v[118:119], v[8:9]
    v_mov_b64 v[120:121], v[8:9]
    v_mov_b64 v[122:123], v[8:9]
    v_mov_b64 v[128:129], v[8:9]
    v_mov_b64 v[130:131], v[8:9]
    v_mov_b64 v[132:133], v[8:9]
    v_mov_b64 v[134:135], v[8:9]
    s_cmp_ge_u32 s3, 8
    s_cbranch_scc1 L_nopub
    v_mov_b64 v[32:33], 0
    v_mov_b64 v[34:35], 0
    v_mov_b64 v[36:37], 0
    v_mov_b64 v[38:39], 0
    v_mov_b64 v[40:41], 0
    v_mov_b64 v[48:49], 0
    v_mov_b64 v[50:51], 0
    v_mov_b64 v[52:53], 0
    v_mov_b64 v[54:55], 0
    v_mov_b64 v[56:57], 0
    v_mov_b64 v[64:65], 0
    v_mov_b64 v[66:67], 0
    v_mov_b64 v[68:69], 0
    v_mov_b64 v[70:71], 0
    v_mov_b64 v[72:73], 0
    v_mov_b64 v[80:81], 0
    v_mov_b64 v[82:83], 0
    v_mov_b64 v[84:85], 0
    v_mov_b64 v[86:87], 0
    v_mov_b64 v[88:89], 0
    s_mov_b32 s76, 0
lw_48:
    ds_read_b32 v164, v166 offset:64
    s_add_u32 s76, s76, 1
    s_waitcnt lgkmcnt(0)
    v_cmp_gt_u32 vcc, 1, v164
    s_cbranch_vccz lwd_49
    s_sleep 1
    s_cmp_lt_u32 s76, 0x40000
    s_cbranch_scc1 lw_48
lwd_49:
    ds_read_b32 v144, v166 offset:48
    v_readfirstlane_b32 s74, v164
    s_waitcnt vmcnt(0) lgkmcnt(0)
    s_mov_b64 exec, 1
    buffer_store_dword v144, v146, s[48:51], s64 offen
    s_mov_b64 exec, -1
    v_mov_b32 v147, 9
    s_mov_b64 exec, 1
    ds_write_b32 v165, v147 offset:0
    s_mov_b64 exec, -1
    v_readfirstlane_b32 s9, v144
    s_cmp_lg_u32 s15, 0
    s_cbranch_scc1 L_nofl
    s_mov_b32 s76, 0
lw_50:
    ds_read_b32 v164, v166 offset:16
    s_add_u32 s76, s76, 1
    s_waitcnt lgkmcnt(0)
    v_cmp_gt_u32 vcc, 9, v164
    s_cbranch_vccz lwd_51
    s_cmp_lt_u32 s76, 0x40000
    s_cbranch_scc1 lw_50
lwd_51:
    s_mov_b64 exec, 0xff
    buffer_store_dword v144, v146, s[48:51], s65 offen sc1
    s_mov_b64 exec, -1
L_nofl:
    s_cmp_lg_u32 s74, 1
    s_cbranch_scc1 L_wla
    s_mov_b64 exec, 3
    s_mov_b32 s76, 0
poll_52:
    buffer_load_dword v164, v12, s[48:51], s92 offen sc1
    s_add_u32 s76, s76, 1
    s_waitcnt vmcnt(0)
    v_cmp_ne_u32 vcc, s9, v164
    s_cbranch_vccz polldone_53
    s_sleep 1
    s_cmp_lt_u32 s76, 40000
    s_cbranch_scc1 poll_52
polldone_53:
    s_mov_b64 exec, -1
    v_mov_b32 v147, 1
    s_mov_b64 exec, 1
    ds_write_b32 v165, v147 offset:80
    s_mov_b64 exec, -1
    s_branch L_ldl
L_nopub:
    v_mov_b64 v[32:33], 0
    v_mov_b64 v[34:35], 0
    v_mov_b64 v[36:37], 0
    v_mov_b64 v[38:39], 0
    v_mov_b64 v[40:41], 0
    v_mov_b64 v[48:49], 0
    v_mov_b64 v[50:51], 0
    v_mov_b64 v[52:53], 0
    v_mov_b64 v[54:55], 0
    v_mov_b64 v[56:57], 0
    v_mov_b64 v[64:65], 0
    v_mov_b64 v[66:67], 0
    v_mov_b64 v[68:69], 0
    v_mov_b64 v[70:71], 0
    v_mov_b64 v[72:73], 0
    v_mov_b64 v[80:81], 0
    v_mov_b64 v[82:83], 0
    v_mov_b64 v[84:85], 0
    v_mov_b64 v[86:87], 0
    v_mov_b64 v[88:89], 0
    s_mov_b32 s76, 0
lw_54:
    ds_read_b32 v164, v166 offset:64
    s_add_u32 s76, s76, 1
    s_waitcnt lgkmcnt(0)
    v_cmp_gt_u32 vcc, 1, v164
    s_cbranch_vccz lwd_55
    s_sleep 1
    s_cmp_lt_u32 s76, 0x40000
    s_cbranch_scc1 lw_54
lwd_55:
    v_cmp_eq_u32 vcc, 1, v164
    s_cbranch_vccnz L_wla2
L_wla:
    v_mov_b32 v147, 10
    s_mov_b64 exec, 1
    ds_write_b32 v165, v147 offset:0
    s_mov_b64 exec, -1
L_wla2:
    s_mov_b32 s76, 0
lw_56:
    ds_read_b32 v164, v160 offset:96
    s_add_u32 s76, s76, 1
    s_waitcnt lgkmcnt(0)
    v_cmp_gt_u32 vcc, 1, v164
    s_cbranch_vccz lwd_57
    s_sleep 1
    s_cmp_lt_u32 s76, 0x40000
    s_cbranch_scc1 lw_56
lwd_57:
L_ldl:
    buffer_load_dwordx4 v[112:115], v163, s[56:59], s72 offen offset:0 sc1
    s_mov_b64 exec, s[70:71]
    buffer_load_dwordx4 v[116:119], v162, s[56:59], s72 offen offset:1024 sc1
    buffer_load_dwordx4 v[120:123], v162, s[56:59], s72 offen offset:1536 sc1
    s_mov_b64 exec, -1
    buffer_load_dwordx4 v[124:127], v163, s[56:59], s72 offen offset:2048 sc1
    s_mov_b64 exec, s[70:71]
    buffer_load_dwordx4 v[128:131], v162, s[56:59], s72 offen offset:3072 sc1
    buffer_load_dwordx4 v[132:135], v162, s[56:59], s72 offen offset:3584 sc1
    s_mov_b64 exec, -1
    v_mov_b32 v164, 10
    s_mov_b64 exec, 1
    ds_write_b32 v165, v164 offset:0
    s_mov_b64 exec, -1
    v_mov_b64 v[140:141], v[8:9]
    v_mov_b64 v[142:143], v[8:9]
    v_mov_b64 v[144:145], v[8:9]
    v_mov_b64 v[146:147], v[8:9]
    v_mov_b64 v[152:153], v[8:9]
    v_mov_b64 v[154:155], v[8:9]
    v_mov_b64 v[156:157], v[8:9]
    v_mov_b64 v[158:159], v[8:9]
    v_mov_b64 v[24:25], 0
    v_mov_b64 v[26:27], 0
    v_mov_b64 v[28:29], 0
    v_mov_b64 v[30:31], 0
    s_mov_b32 s76, 0
lw_58:
    ds_read_b32 v164, v166 offset:32
    s_add_u32 s76, s76, 1
    s_waitcnt lgkmcnt(0)
    v_cmp_gt_u32 vcc, 3, v164
    s_cbranch_vccz lwd_59
    s_sleep 1
    s_cmp_lt_u32 s76, 0x40000
    s_cbranch_scc1 lw_58
lwd_59:
    ds_read_b128 v[96:99], v11
    ds_read_b128 v[100:103], v11 offset:4096
    ds_read_b128 v[104:107], v11 offset:8192
    ds_read_b128 v[108:111], v11 offset:12288
    s_mov_b32 s75, 0
    s_mov_b32 s78, 1
    s_mov_b32 s73, 0x20000
    s_setprio 3
    s_waitcnt vmcnt(3) lgkmcnt(0)
    v_mfma_f32_32x32x16_bf16 v[0:15], v[112:115], v[96:99], 0
    s_nop 11
.p2align 6
L_loop:
    v_exp_f32 v0, v0
    v_exp_f32 v1, v1
    v_exp_f32 v2, v2
    v_smfmac_f32_32x32x32_bf16 v[80:95], v[156:159], v[24:31], v161
    v_exp_f32 v3, v3
    v_exp_f32 v4, v4
    v_exp_f32 v5, v5
    v_exp_f32 v6, v6
    v_exp_f32 v7, v7
    v_mfma_f32_32x32x16_bf16 v[16:31], v[112:115], v[100:103], 0
    s_cmp_lg_u32 s78, 0
    s_cbranch_scc1 L_stubR0
L_norR0:
    buffer_load_dwordx4 v[148:151], v163, s[56:59], s72 offen offset:2048 sc1
    s_mov_b64 exec, s[70:71]
    buffer_load_dwordx4 v[152:155], v162, s[56:59], s72 offen offset:3072 sc1
    buffer_load_dwordx4 v[156:159], v162, s[56:59], s72 offen offset:3584 sc1
    s_mov_b64 exec, -1
L_retR0:
    v_exp_f32 v8, v8
    v_exp_f32 v9, v9
    v_exp_f32 v10, v10
    v_exp_f32 v11, v11
    v_exp_f32 v12, v12
    v_smfmac_f32_32x32x32_bf16 v[32:47], v[116:119], v[0:7], v161
    v_exp_f32 v13, v13
    v_exp_f32 v14, v14
    v_exp_f32 v15, v15
    v_exp_f32 v16, v16
    v_exp_f32 v17, v17
    v_exp_f32 v18, v18
    v_smfmac_f32_32x32x32_bf16 v[32:47], v[120:123], v[8:15], v161
    v_exp_f32 v19, v19
    v_exp_f32 v20, v20
    v_exp_f32 v21, v21
    v_exp_f32 v22, v22
    v_exp_f32 v23, v23
    v_mfma_f32_32x32x16_bf16 v[0:15], v[112:115], v[104:107], 0
    v_exp_f32 v24, v24
    v_exp_f32 v25, v25
    v_exp_f32 v26, v26
    v_exp_f32 v27, v27
    v_exp_f32 v28, v28
    v_smfmac_f32_32x32x32_bf16 v[48:63], v[116:119], v[16:23], v161
    v_exp_f32 v29, v29
    v_exp_f32 v30, v30
    v_exp_f32 v31, v31
    v_exp_f32 v0, v0
    v_exp_f32 v1, v1
    v_exp_f32 v2, v2
    v_smfmac_f32_32x32x32_bf16 v[48:63], v[120:123], v[24:31], v161
    v_exp_f32 v3, v3
    v_exp_f32 v4, v4
    v_exp_f32 v5, v5
    v_exp_f32 v6, v6
    v_exp_f32 v7, v7
    v_mfma_f32_32x32x16_bf16 v[16:31], v[112:115], v[108:111], 0
    v_exp_f32 v8, v8
    v_exp_f32 v9, v9
    v_exp_f32 v10, v10
    v_exp_f32 v11, v11
    v_exp_f32 v12, v12
    v_smfmac_f32_32x32x32_bf16 v[64:79], v[116:119], v[0:7], v161
    v_exp_f32 v13, v13
    v_exp_f32 v14, v14
    v_exp_f32 v15, v15
    v_exp_f32 v16, v16
    v_exp_f32 v17, v17
    v_exp_f32 v18, v18
    v_smfmac_f32_32x32x32_bf16 v[64:79], v[120:123], v[8:15], v161
    v_exp_f32 v19, v19
    v_exp_f32 v20, v20
    v_exp_f32 v21, v21
    v_exp_f32 v22, v22
    v_exp_f32 v23, v23
    s_cmp_lg_u32 s78, 0
    s_cbranch_scc1 L_stubW0
L_retW0:
    s_waitcnt vmcnt(6)
    v_mfma_f32_32x32x16_bf16 v[0:15], v[124:127], v[96:99], 0
    v_exp_f32 v24, v24
    v_exp_f32 v25, v25
    v_exp_f32 v26, v26
    v_exp_f32 v27, v27
    v_exp_f32 v28, v28
    v_smfmac_f32_32x32x32_bf16 v[80:95], v[116:119], v[16:23], v161
    v_exp_f32 v29, v29
    v_exp_f32 v30, v30
    v_exp_f32 v31, v31
    v_exp_f32 v0, v0
    v_exp_f32 v1, v1
    v_exp_f32 v2, v2
    v_smfmac_f32_32x32x32_bf16 v[80:95], v[120:123], v[24:31], v161
    v_exp_f32 v3, v3
    v_exp_f32 v4, v4
    v_exp_f32 v5, v5
    v_exp_f32 v6, v6
    v_exp_f32 v7, v7
    v_mfma_f32_32x32x16_bf16 v[16:31], v[124:127], v[100:103], 0
    s_cmp_lg_u32 s78, 0
    s_cbranch_scc1 L_stubR1
L_norR1:
    s_add_u32 s72, s72, 0x4000
    s_and_b32 s72, s72, 0x1ffff
    s_mov_b32 s58, s73
    buffer_load_dwordx4 v[112:115], v163, s[56:59], s72 offen offset:0 sc1
    s_mov_b64 exec, s[70:71]
    buffer_load_dwordx4 v[116:119], v162, s[56:59], s72 offen offset:1024 sc1
    buffer_load_dwordx4 v[120:123], v162, s[56:59], s72 offen offset:1536 sc1
    s_mov_b64 exec, -1
L_retR1:
    v_exp_f32 v8, v8
    v_exp_f32 v9, v9
    v_exp_f32 v10, v10
    v_exp_f32 v11, v11
    v_exp_f32 v12, v12
    v_smfmac_f32_32x32x32_bf16 v[32:47], v[128:131], v[0:7], v161
    v_exp_f32 v13, v13
    v_exp_f32 v14, v14
    v_exp_f32 v15, v15
    v_exp_f32 v16, v16
    v_exp_f32 v17, v17
    v_exp_f32 v18, v18
    v_smfmac_f32_32x32x32_bf16 v[32:47], v[132:135], v[8:15], v161
    v_exp_f32 v19, v19
    v_exp_f32 v20, v20
    v_exp_f32 v21, v21
    v_exp_f32 v22, v22
    v_exp_f32 v23, v23
    v_mfma_f32_32x32x16_bf16 v[0:15], v[124:127], v[104:107], 0
    v_exp_f32 v24, v24
    v_exp_f32 v25, v25
    v_exp_f32 v26, v26
    v_exp_f32 v27, v27
    v_exp_f32 v28, v28
    v_smfmac_f32_32x32x32_bf16 v[48:63], v[128:131], v[16:23], v161
    v_exp_f32 v29, v29
    v_exp_f32 v30, v30
    v_exp_f32 v31, v31
    v_exp_f32 v0, v0
    v_exp_f32 v1, v1
    v_exp_f32 v2, v2
    v_smfmac_f32_32x32x32_bf16 v[48:63], v[132:135], v[24:31], v161
    v_exp_f32 v3, v3
    v_exp_f32 v4, v4
    v_exp_f32 v5, v5
    v_exp_f32 v6, v6
    v_exp_f32 v7, v7
    v_mfma_f32_32x32x16_bf16 v[16:31], v[124:127], v[108:111], 0
    v_exp_f32 v8, v8
    v_exp_f32 v9, v9
    v_exp_f32 v10, v10
    v_exp_f32 v11, v11
    v_exp_f32 v12, v12
    v_smfmac_f32_32x32x32_bf16 v[64:79], v[128:131], v[0:7], v161
    v_exp_f32 v13, v13
    v_exp_f32 v14, v14
    v_exp_f32 v15, v15
    v_exp_f32 v16, v16
    v_exp_f32 v17, v17
    v_exp_f32 v18, v18
    v_smfmac_f32_32x32x32_bf16 v[64:79], v[132:135], v[8:15], v161
    v_exp_f32 v19, v19
    v_exp_f32 v20, v20
    v_exp_f32 v21, v21
    v_exp_f32 v22, v22
    v_exp_f32 v23, v23
    s_cmp_lg_u32 s78, 0
    s_cbranch_scc1 L_stubW1
L_retW1:
    s_waitcnt vmcnt(6)
    v_mfma_f32_32x32x16_bf16 v[0:15], v[136:139], v[96:99], 0
    v_exp_f32 v24, v24
    v_exp_f32 v25, v25
    v_exp_f32 v26, v26
    v_exp_f32 v27, v27
    v_exp_f32 v28, v28
    v_smfmac_f32_32x32x32_bf16 v[80:95], v[128:131], v[16:23], v161
    v_exp_f32 v29, v29
    v_exp_f32 v30, v30
    v_exp_f32 v31, v31
    v_exp_f32 v0, v0
    v_exp_f32 v1, v1
    v_exp_f32 v2, v2
    v_smfmac_f32_32x32x32_bf16 v[80:95], v[132:135], v[24:31], v161
    v_exp_f32 v3, v3
    v_exp_f32 v4, v4
    v_exp_f32 v5, v5
    v_exp_f32 v6, v6
    v_exp_f32 v7, v7
    v_mfma_f32_32x32x16_bf16 v[16:31], v[136:139], v[100:103], 0
    buffer_load_dwordx4 v[124:127], v163, s[56:59], s72 offen offset:2048 sc1
    s_mov_b64 exec, s[70:71]
    buffer_load_dwordx4 v[128:131], v162, s[56:59], s72 offen offset:3072 sc1
    buffer_load_dwordx4 v[132:135], v162, s[56:59], s72 offen offset:3584 sc1
    s_mov_b64 exec, -1
    v_exp_f32 v8, v8
    v_exp_f32 v9, v9
    v_exp_f32 v10, v10
    v_exp_f32 v11, v11
    v_exp_f32 v12, v12
    v_smfmac_f32_32x32x32_bf16 v[32:47], v[140:143], v[0:7], v161
    v_exp_f32 v13, v13
    v_exp_f32 v14, v14
    v_exp_f32 v15, v15
    v_exp_f32 v16, v16
    v_exp_f32 v17, v17
    v_exp_f32 v18, v18
    v_smfmac_f32_32x32x32_bf16 v[32:47], v[144:147], v[8:15], v161
    v_exp_f32 v19, v19
    v_exp_f32 v20, v20
    v_exp_f32 v21, v21
    v_exp_f32 v22, v22
    v_exp_f32 v23, v23
    v_mfma_f32_32x32x16_bf16 v[0:15], v[136:139], v[104:107], 0
    v_exp_f32 v24, v24
    v_exp_f32 v25, v25
    v_exp_f32 v26, v26
    v_exp_f32 v27, v27
    v_exp_f32 v28, v28
    v_smfmac_f32_32x32x32_bf16 v[48:63], v[140:143], v[16:23], v161
    v_exp_f32 v29, v29
    v_exp_f32 v30, v30
    v_exp_f32 v31, v31
    v_exp_f32 v0, v0
    v_exp_f32 v1, v1
    v_exp_f32 v2, v2
    v_smfmac_f32_32x32x32_bf16 v[48:63], v[144:147], v[24:31], v161
    v_exp_f32 v3, v3
    v_exp_f32 v4, v4
    v_exp_f32 v5, v5
    v_exp_f32 v6, v6
    v_exp_f32 v7, v7
    v_mfma_f32_32x32x16_bf16 v[16:31], v[136:139], v[108:111], 0
    v_exp_f32 v8, v8
    v_exp_f32 v9, v9
    v_exp_f32 v10, v10
    v_exp_f32 v11, v11
    v_exp_f32 v12, v12
    v_smfmac_f32_32x32x32_bf16 v[64:79], v[140:143], v[0:7], v161
    v_exp_f32 v13, v13
    v_exp_f32 v14, v14
    v_exp_f32 v15, v15
    v_exp_f32 v16, v16
    v_exp_f32 v17, v17
    v_exp_f32 v18, v18
    v_smfmac_f32_32x32x32_bf16 v[64:79], v[144:147], v[8:15], v161
    v_exp_f32 v19, v19
    v_exp_f32 v20, v20
    v_exp_f32 v21, v21
    v_exp_f32 v22, v22
    v_exp_f32 v23, v23
    s_waitcnt vmcnt(6)
    v_mfma_f32_32x32x16_bf16 v[0:15], v[148:151], v[96:99], 0
    v_exp_f32 v24, v24
    v_exp_f32 v25, v25
    v_exp_f32 v26, v26
    v_exp_f32 v27, v27
    v_exp_f32 v28, v28
    v_smfmac_f32_32x32x32_bf16 v[80:95], v[140:143], v[16:23], v161
    v_exp_f32 v29, v29
    v_exp_f32 v30, v30
    v_exp_f32 v31, v31
    v_exp_f32 v0, v0
    v_exp_f32 v1, v1
    v_exp_f32 v2, v2
    v_smfmac_f32_32x32x32_bf16 v[80:95], v[144:147], v[24:31], v161
    v_exp_f32 v3, v3
    v_exp_f32 v4, v4
    v_exp_f32 v5, v5
    v_exp_f32 v6, v6
    v_exp_f32 v7, v7
    v_mfma_f32_32x32x16_bf16 v[16:31], v[148:151], v[100:103], 0
    s_add_u32 s72, s72, 0x4000
    s_and_b32 s72, s72, 0x1ffff
    buffer_load_dwordx4 v[136:139], v163, s[56:59], s72 offen offset:0 sc1
    s_mov_b64 exec, s[70:71]
    buffer_load_dwordx4 v[140:143], v162, s[56:59], s72 offen offset:1024 sc1
    buffer_load_dwordx4 v[144:147], v162, s[56:59], s72 offen offset:1536 sc1
    s_mov_b64 exec, -1
    v_exp_f32 v8, v8
    v_exp_f32 v9, v9
    v_exp_f32 v10, v10
    v_exp_f32 v11, v11
    v_exp_f32 v12, v12
    v_smfmac_f32_32x32x32_bf16 v[32:47], v[152:155], v[0:7], v161
    v_exp_f32 v13, v13
    v_exp_f32 v14, v14
    v_exp_f32 v15, v15
    v_exp_f32 v16, v16
    v_exp_f32 v17, v17
    v_exp_f32 v18, v18
    v_smfmac_f32_32x32x32_bf16 v[32:47], v[156:159], v[8:15], v161
    v_exp_f32 v19, v19
    v_exp_f32 v20, v20
    v_exp_f32 v21, v21
    v_exp_f32 v22, v22
    v_exp_f32 v23, v23
    v_mfma_f32_32x32x16_bf16 v[0:15], v[148:151], v[104:107], 0
    v_exp_f32 v24, v24
    v_exp_f32 v25, v25
    v_exp_f32 v26, v26
    v_exp_f32 v27, v27
    v_exp_f32 v28, v28
    v_smfmac_f32_32x32x32_bf16 v[48:63], v[152:155], v[16:23], v161
    v_exp_f32 v29, v29
    v_exp_f32 v30, v30
    v_exp_f32 v31, v31
    v_exp_f32 v0, v0
    v_exp_f32 v1, v1
    v_exp_f32 v2, v2
    v_smfmac_f32_32x32x32_bf16 v[48:63], v[156:159], v[24:31], v161
    v_exp_f32 v3, v3
    v_exp_f32 v4, v4
    v_exp_f32 v5, v5
    v_exp_f32 v6, v6
    v_exp_f32 v7, v7
    v_mfma_f32_32x32x16_bf16 v[16:31], v[148:151], v[108:111], 0
    v_exp_f32 v8, v8
    v_exp_f32 v9, v9
    v_exp_f32 v10, v10
    v_exp_f32 v11, v11
    v_exp_f32 v12, v12
    v_smfmac_f32_32x32x32_bf16 v[64:79], v[152:155], v[0:7], v161
    v_exp_f32 v13, v13
    v_exp_f32 v14, v14
    v_exp_f32 v15, v15
    v_exp_f32 v16, v16
    v_exp_f32 v17, v17
    v_exp_f32 v18, v18
    v_smfmac_f32_32x32x32_bf16 v[64:79], v[156:159], v[8:15], v161
    v_exp_f32 v19, v19
    v_exp_f32 v20, v20
    v_exp_f32 v21, v21
    v_exp_f32 v22, v22
    v_exp_f32 v23, v23
    s_waitcnt vmcnt(6)
    v_mfma_f32_32x32x16_bf16 v[0:15], v[112:115], v[96:99], 0
    v_exp_f32 v24, v24
    v_exp_f32 v25, v25
    v_exp_f32 v26, v26
    v_exp_f32 v27, v27
    v_exp_f32 v28, v28
    v_smfmac_f32_32x32x32_bf16 v[80:95], v[152:155], v[16:23], v161
    v_exp_f32 v29, v29
    v_exp_f32 v30, v30
    v_exp_f32 v31, v31
    s_add_u32 s75, s75, 1
    s_cmp_eq_u32 s75, 4
    s_cbranch_scc1 L_rend
    s_cmp_lg_u32 s75, 1
    s_cbranch_scc1 pr_60
    s_setprio 2
    s_branch L_loop
pr_60:
    s_cmp_lg_u32 s75, 2
    s_cbranch_scc1 pr_61
    s_setprio 1
    s_branch L_loop
pr_61:
    s_setprio 0
    s_mov_b32 s73, 0
    s_branch L_loop
L_stubR0:
    ds_read_b32 v164, v166 offset:80
    s_waitcnt lgkmcnt(0)
    v_cmp_le_u32 vcc, 1, v164
    s_cbranch_vccz L_retR0
    s_mov_b32 s78, 0
    s_add_u32 s72, s72, 0x4000
    s_and_b32 s72, s72, 0x1ffff
    buffer_load_dwordx4 v[136:139], v163, s[56:59], s72 offen offset:0 sc1
    s_mov_b64 exec, s[70:71]
    buffer_load_dwordx4 v[140:143], v162, s[56:59], s72 offen offset:1024 sc1
    buffer_load_dwordx4 v[144:147], v162, s[56:59], s72 offen offset:1536 sc1
    s_mov_b64 exec, -1
    v_mov_b32 v164, 11
    s_mov_b64 exec, 1
    ds_write_b32 v165, v164 offset:0
    s_mov_b64 exec, -1
    s_branch L_norR0
L_stubW0:
    s_waitcnt vmcnt(0)
    s_branch L_retW0
L_stubR1:
    ds_read_b32 v164, v166 offset:80
    s_waitcnt lgkmcnt(0)
    v_cmp_le_u32 vcc, 1, v164
    s_cbranch_vccz L_retR1
    s_mov_b32 s78, 3
    s_branch L_fill
L_stubW1:
    s_mov_b32 s76, 0
lw_63:
    ds_read_b32 v164, v166 offset:80
    s_add_u32 s76, s76, 1
    s_waitcnt lgkmcnt(0)
    v_cmp_gt_u32 vcc, 1, v164
    s_cbranch_vccz lwd_64
    s_sleep 1
    s_cmp_lt_u32 s76, 0x40000
    s_cbranch_scc1 lw_63
lwd_64:
L_fill:
    s_add_u32 s72, s72, 0x4000
    s_and_b32 s72, s72, 0x1ffff
    buffer_load_dwordx4 v[136:139], v163, s[56:59], s72 offen offset:0 sc1
    s_mov_b64 exec, s[70:71]
    buffer_load_dwordx4 v[140:143], v162, s[56:59], s72 offen offset:1024 sc1
    buffer_load_dwordx4 v[144:147], v162, s[56:59], s72 offen offset:1536 sc1
    s_mov_b64 exec, -1
    buffer_load_dwordx4 v[148:151], v163, s[56:59], s72 offen offset:2048 sc1
    s_mov_b64 exec, s[70:71]
    buffer_load_dwordx4 v[152:155], v162, s[56:59], s72 offen offset:3072 sc1
    buffer_load_dwordx4 v[156:159], v162, s[56:59], s72 offen offset:3584 sc1
    s_mov_b64 exec, -1
    s_add_u32 s72, s72, 0x4000
    s_and_b32 s72, s72, 0x1ffff
    buffer_load_dwordx4 v[112:115], v163, s[56:59], s72 offen offset:0 sc1
    s_mov_b64 exec, s[70:71]
    buffer_load_dwordx4 v[116:119], v162, s[56:59], s72 offen offset:1024 sc1
    buffer_load_dwordx4 v[120:123], v162, s[56:59], s72 offen offset:1536 sc1
    s_mov_b64 exec, -1
    v_mov_b32 v164, 11
    s_mov_b64 exec, 1
    ds_write_b32 v165, v164 offset:0
    s_mov_b64 exec, -1
    s_cmp_eq_u32 s78, 3
    s_mov_b32 s78, 0
    s_cbranch_scc1 L_retR1
    s_branch L_retW1
L_rend:
    v_smfmac_f32_32x32x32_bf16 v[80:95], v[156:159], v[24:31], v161
    s_setprio 3
    ds_read_b32 v2, v166 offset:64
    s_mul_i32 s10, s3, 9216
    s_add_u32 s10, s10, -20480
    v_add_u32 v160, s10, v163
    v_lshrrev_b32 v4, 2, v163
    v_add_u32 v164, s10, v4
    s_lshl_b32 s10, s14, 4
    v_add_u32 v166, s10, v166
    ds_write_b128 v160, v[32:35] offset:0
    ds_write_b128 v160, v[36:39] offset:1024
    ds_write_b32 v164, v40 offset:2048
    ds_write_b128 v160, v[48:51] offset:2304
    ds_write_b128 v160, v[52:55] offset:3328
    ds_write_b32 v164, v56 offset:4352
    ds_write_b128 v160, v[64:67] offset:4608
    ds_write_b128 v160, v[68:71] offset:5632
    ds_write_b32 v164, v72 offset:6656
    ds_write_b128 v160, v[80:83] offset:6912
    ds_write_b128 v160, v[84:87] offset:7936
    ds_write_b32 v164, v88 offset:8960
    s_mul_i32 s10, s14, 36864
    s_mul_i32 s11, s15, 2304
    s_add_u32 s10, s10, s11
    s_add_u32 s10, s10, 16384
    v_add_u32 v5, s10, v163
    v_and_b32 v4, 0x7f, v4
    v_add_u32 v6, s10, v4
    s_lshl_b32 s10, s6, 2
    s_add_u32 s10, s10, s15
    s_lshl_b32 s10, s10, 5
    s_lshl_b32 s77, s7, 1
    s_add_u32 s77, s77, s14
    s_add_u32 s10, s10, s77
    s_lshl_b32 s63, s10, 10
    s_add_u32 s63, s63, 0x400000
    s_lshl_b32 s64, s10, 7
    s_add_u32 s64, s64, 0x640000
    v_mov_b32 v7, 0x207
    v_mov_b32 v8, s9
    v_mov_b32 v9, 0
    s_mov_b32 s12, 0x2b800000
    s_mov_b32 s13, 0x5d800000
    s_waitcnt lgkmcnt(0)
    v_mov_b32 v164, 12
    s_mov_b64 exec, 1
    ds_write_b32 v165, v164 offset:0
    s_mov_b64 exec, -1
    v_readfirstlane_b32 s74, v2
    s_mov_b32 s76, 0
lw_65:
    ds_read_b32 v164, v166 offset:16
    s_add_u32 s76, s76, 1
    s_waitcnt lgkmcnt(0)
    v_cmp_gt_u32 vcc, 12, v164
    s_cbranch_vccz lwd_66
    s_sleep 1
    s_cmp_lt_u32 s76, 0x40000
    s_cbranch_scc1 lw_65
lwd_66:
    ds_read_b128 v[16:19], v5 offset:0
    ds_read_b128 v[20:23], v5 offset:1024
    ds_read_b32 v24, v6 offset:2048
    ds_read_b128 v[28:31], v5 offset:9216
    ds_read_b128 v[32:35], v5 offset:10240
    ds_read_b32 v36, v6 offset:11264
    ds_read_b128 v[40:43], v5 offset:18432
    ds_read_b128 v[44:47], v5 offset:19456
    ds_read_b32 v48, v6 offset:20480
    ds_read_b128 v[52:55], v5 offset:27648
    ds_read_b128 v[56:59], v5 offset:28672
    ds_read_b32 v60, v6 offset:29696
    s_waitcnt lgkmcnt(6)
    v_pk_add_f32 v[16:17], v[16:17], v[28:29]
    v_pk_add_f32 v[18:19], v[18:19], v[30:31]
    v_pk_add_f32 v[20:21], v[20:21], v[32:33]
    v_pk_add_f32 v[22:23], v[22:23], v[34:35]
    v_add_f32 v24, v24, v36
    s_waitcnt lgkmcnt(0)
    v_add_f32 v48, v48, v60
    v_pk_add_f32 v[40:41], v[40:41], v[52:53]
    v_pk_add_f32 v[42:43], v[42:43], v[54:55]
    v_pk_add_f32 v[44:45], v[44:45], v[56:57]
    v_pk_add_f32 v[46:47], v[46:47], v[58:59]
    v_add_f32 v24, v24, v48
    v_pk_add_f32 v[16:17], v[16:17], v[40:41]
    v_pk_add_f32 v[18:19], v[18:19], v[42:43]
    v_rcp_f32 v26, v24
    v_pk_add_f32 v[20:21], v[20:21], v[44:45]
    v_pk_add_f32 v[22:23], v[22:23], v[46:47]
    v_cmp_nle_f32 s[10:11], s12, v24
    v_cmp_nge_f32 s[12:13], s13, v24
    v_pk_mul_f32 v[16:17], v[16:17], v[26:27] op_sel_hi:[1,0]
    v_pk_mul_f32 v[18:19], v[18:19], v[26:27] op_sel_hi:[1,0]
    v_pk_mul_f32 v[20:21], v[20:21], v[26:27] op_sel_hi:[1,0]
    v_pk_mul_f32 v[22:23], v[22:23], v[26:27] op_sel_hi:[1,0]
    v_pk_add_f32 v[28:29], v[16:17], v[18:19]
    v_pk_add_f32 v[30:31], v[20:21], v[22:23]
    v_cvt_pk_bf16_f32 v88, v16, v17
    v_pk_add_f32 v[28:29], v[28:29], v[30:31]
    v_cvt_pk_bf16_f32 v89, v18, v19
    v_add_f32 v28, v28, v29
    v_cvt_pk_bf16_f32 v90, v20, v21
    v_cmp_class_f32 vcc, v28, v7
    v_cvt_pk_bf16_f32 v91, v22, v23
    s_or_b64 s[10:11], s[10:11], s[12:13]
    s_or_b64 vcc, vcc, s[10:11]
    s_cbranch_vccnz L_fallback
L_ost:
    s_cmp_eq_u32 s74, 1
    s_cbranch_scc0 L_ostr
    buffer_store_dwordx4 v[88:91], v163, s[48:51], s63 offen
    s_mov_b64 exec, 1
    s_waitcnt vmcnt(0)
    buffer_store_dword v8, v9, s[48:51], s64 offen
    s_mov_b64 exec, -1
    s_branch L_exit
L_ostr:
    buffer_store_dwordx4 v[88:91], v163, s[48:51], s63 offen sc1
    s_mov_b64 exec, 1
    s_waitcnt vmcnt(0)
    buffer_store_dword v8, v9, s[48:51], s64 offen sc1
    s_mov_b64 exec, -1
    s_branch L_exit
L_fallback:
    s_lshl_b32 s10, s15, 12
    s_lshl_b32 s11, s14, 10
    s_add_u32 s10, s10, s11
    v_add_u32 v16, s10, v163
    ds_read_b128 v[76:79], v16
    v_mov_b32 v48, 0xff800000
    s_lshl_b32 s10, s77, 17
    s_mov_b32 s11, 64
    s_waitcnt lgkmcnt(0)
L_fb1:
    buffer_load_dwordx4 v[64:67], v163, s[48:51], s10 offen sc1
    s_add_u32 s10, s10, 0x800
    s_waitcnt vmcnt(0)
    v_mfma_f32_32x32x16_bf16 v[16:31], v[64:67], v[76:79], 0
    s_nop 12
    v_max3_f32 v48, v16, v17, v48
    v_max3_f32 v48, v18, v19, v48
    v_max3_f32 v48, v20, v21, v48
    v_max3_f32 v48, v22, v23, v48
    v_max3_f32 v48, v24, v25, v48
    v_max3_f32 v48, v26, v27, v48
    v_max3_f32 v48, v28, v29, v48
    v_max3_f32 v48, v30, v31, v48
    s_sub_u32 s11, s11, 1
    s_cmp_lg_u32 s11, 0
    s_cbranch_scc1 L_fb1
    v_mov_b32 v49, v48
    s_nop 1
    v_permlane32_swap_b32 v48, v49
    s_nop 1
    v_max_f32 v48, v48, v49
    v_xor_b32 v32, 0x80000000, v48
    v_xor_b32 v33, 0x80000000, v48
    v_xor_b32 v34, 0x80000000, v48
    v_xor_b32 v35, 0x80000000, v48
    v_xor_b32 v36, 0x80000000, v48
    v_xor_b32 v37, 0x80000000, v48
    v_xor_b32 v38, 0x80000000, v48
    v_xor_b32 v39, 0x80000000, v48
    v_xor_b32 v40, 0x80000000, v48
    v_xor_b32 v41, 0x80000000, v48
    v_xor_b32 v42, 0x80000000, v48
    v_xor_b32 v43, 0x80000000, v48
    v_xor_b32 v44, 0x80000000, v48
    v_xor_b32 v45, 0x80000000, v48
    v_xor_b32 v46, 0x80000000, v48
    v_xor_b32 v47, 0x80000000, v48
    v_mov_b64 v[48:49], 0
    v_mov_b64 v[50:51], 0
    v_mov_b64 v[52:53], 0
    v_mov_b64 v[54:55], 0
    v_mov_b64 v[56:57], 0
    v_mov_b64 v[58:59], 0
    v_mov_b64 v[60:61], 0
    v_mov_b64 v[62:63], 0
    v_mov_b32 v68, 0x3f803f80
    v_mov_b32 v69, 0x3f803f80
    v_mov_b32 v70, 0x3f803f80
    v_mov_b32 v71, 0x3f803f80
    v_mov_b32 v72, 0x3f803f80
    v_mov_b32 v73, 0x3f803f80
    v_mov_b32 v74, 0x3f803f80
    v_mov_b32 v75, 0x3f803f80
    s_lshl_b32 s10, s77, 17
    s_mov_b32 s11, 64
L_fb2:
    buffer_load_dwordx4 v[64:67], v163, s[48:51], s10 offen sc1
    s_mov_b64 exec, s[70:71]
    buffer_load_dwordx4 v[68:71], v162, s[48:51], s10 offen offset:1024 sc1
    buffer_load_dwordx4 v[72:75], v162, s[48:51], s10 offen offset:1536 sc1
    s_mov_b64 exec, -1
    s_add_u32 s10, s10, 0x800
    s_waitcnt vmcnt(0)
    v_mfma_f32_32x32x16_bf16 v[16:31], v[64:67], v[76:79], v[32:47]
    s_nop 12
    v_exp_f32 v16, v16
    v_exp_f32 v17, v17
    v_exp_f32 v18, v18
    v_exp_f32 v19, v19
    v_exp_f32 v20, v20
    v_exp_f32 v21, v21
    v_exp_f32 v22, v22
    v_exp_f32 v23, v23
    v_exp_f32 v24, v24
    v_exp_f32 v25, v25
    v_exp_f32 v26, v26
    v_exp_f32 v27, v27
    v_exp_f32 v28, v28
    v_exp_f32 v29, v29
    v_exp_f32 v30, v30
    v_exp_f32 v31, v31
    s_nop 1
    v_smfmac_f32_32x32x32_bf16 v[48:63], v[68:71], v[16:23], v161
    v_smfmac_f32_32x32x32_bf16 v[48:63], v[72:75], v[24:31], v161
    s_sub_u32 s11, s11, 1
    s_cmp_lg_u32 s11, 0
    s_cbranch_scc1 L_fb2
    s_nop 12
    v_rcp_f32 v56, v56
    s_nop 0
    v_mul_f32 v48, v48, v56
    v_mul_f32 v49, v49, v56
    v_mul_f32 v50, v50, v56
    v_mul_f32 v51, v51, v56
    v_mul_f32 v52, v52, v56
    v_mul_f32 v53, v53, v56
    v_mul_f32 v54, v54, v56
    v_mul_f32 v55, v55, v56
    v_cvt_pk_bf16_f32 v88, v48, v49
    v_cvt_pk_bf16_f32 v89, v50, v51
    v_cvt_pk_bf16_f32 v90, v52, v53
    v_cvt_pk_bf16_f32 v91, v54, v55
    s_branch L_ost
L_h012:
    s_mov_b32 s76, 0
lw_9:
    ds_read_b32 v164, v166 offset:16
    s_add_u32 s76, s76, 1
    s_waitcnt lgkmcnt(0)
    v_cmp_gt_u32 vcc, 11, v164
    s_cbranch_vccz lwd_10
    s_sleep 8
    s_cmp_lt_u32 s76, 0x40000
    s_cbranch_scc1 lw_9
lwd_10:
    s_mov_b32 s76, 0
lw_11:
    ds_read_b32 v164, v166 offset:32
    s_add_u32 s76, s76, 1
    s_waitcnt lgkmcnt(0)
    v_cmp_gt_u32 vcc, 11, v164
    s_cbranch_vccz lwd_12
    s_sleep 8
    s_cmp_lt_u32 s76, 0x40000
    s_cbranch_scc1 lw_11
lwd_12:
    s_cmp_lg_u32 s3, 3
    s_cbranch_scc1 L_norg
    s_mov_b32 s76, 0
lw_13:
    ds_read_b32 v164, v166 offset:0
    s_add_u32 s76, s76, 1
    s_waitcnt lgkmcnt(0)
    v_cmp_gt_u32 vcc, 4, v164
    s_cbranch_vccz lwd_14
    s_sleep 1
    s_cmp_lt_u32 s76, 0x40000
    s_cbranch_scc1 lw_13
lwd_14:
    v_add_u32 v2, 163328, v163
    s_mov_b64 exec, 15
    ds_read_b128 v[116:119], v2
    s_lshr_b32 s11, s89, 2
    s_lshl_b32 s11, s11, 7
    s_add_u32 s11, s11, 0x820000
    s_waitcnt lgkmcnt(0)
    buffer_store_dwordx4 v[116:119], v163, s[48:51], s11 offen sc1
    s_mov_b64 exec, -1
    s_cmp_eq_u32 s2, 255
    s_cbranch_scc1 L_sel
L_norg:
    s_cmp_lt_u32 s2, 172
    s_cbranch_scc1 L_nob
    s_cmp_lt_u32 s2, 215
    s_cbranch_scc1 L_moeB
L_nob:
    s_cmp_ge_u32 s3, 2
    s_cbranch_scc1 L_nowo
L_wo:
    s_mov_b64 s[52:53], s[20:21]
    s_mov_b32 s54, 0x80000
    s_mov_b32 s55, 0x20000
    s_lshl_b32 s10, s3, 18
    s_lshl_b32 s11, s7, 6
    s_add_u32 s10, s10, s11
    s_lshl_b32 s11, s3, 14
    s_add_u32 s11, s11, 90112
    s_mov_b32 s12, 16
L_dmawo:
    s_mov_b32 m0, s11
    s_add_u32 s11, s11, 0x400
    buffer_load_dwordx4 v15, s[52:55], s10 offen lds
    s_add_u32 s10, s10, 0x4000
    s_sub_u32 s12, s12, 1
    s_waitcnt vmcnt(2)
    s_cmp_lg_u32 s12, 0
    s_cbranch_scc1 L_dmawo
    s_waitcnt vmcnt(0)
    s_branch L_outproj
L_nowo:
    s_cmp_eq_u32 s3, 3
    s_cbranch_scc1 L_outproj
    s_cmp_lt_u32 s2, 172
    s_cbranch_scc1 L_moeA
    s_branch L_outproj
L_sel:
    v_lshl_add_u32 v4, v7, 7, v8
    s_waitcnt vmcnt(0)
    s_mov_b32 s76, 0
L_keys:
    s_mov_b32 s10, 0x820000
    buffer_load_dwordx2 v[16:17], v4, s[48:51], s10 offen offset:0 sc1
    buffer_load_dwordx2 v[18:19], v4, s[48:51], s10 offen offset:2048 sc1
    s_add_u32 s10, s10, 0x1000
    buffer_load_dwordx2 v[20:21], v4, s[48:51], s10 offen offset:0 sc1
    buffer_load_dwordx2 v[22:23], v4, s[48:51], s10 offen offset:2048 sc1
    s_add_u32 s10, s10, 0x1000
    buffer_load_dwordx2 v[24:25], v4, s[48:51], s10 offen offset:0 sc1
    buffer_load_dwordx2 v[26:27], v4, s[48:51], s10 offen offset:2048 sc1
    s_add_u32 s10, s10, 0x1000
    buffer_load_dwordx2 v[28:29], v4, s[48:51], s10 offen offset:0 sc1
    buffer_load_dwordx2 v[30:31], v4, s[48:51], s10 offen offset:2048 sc1
    s_add_u32 s10, s10, 0x1000
    buffer_load_dwordx2 v[32:33], v4, s[48:51], s10 offen offset:0 sc1
    buffer_load_dwordx2 v[34:35], v4, s[48:51], s10 offen offset:2048 sc1
    s_add_u32 s10, s10, 0x1000
    buffer_load_dwordx2 v[36:37], v4, s[48:51], s10 offen offset:0 sc1
    buffer_load_dwordx2 v[38:39], v4, s[48:51], s10 offen offset:2048 sc1
    s_add_u32 s10, s10, 0x1000
    buffer_load_dwordx2 v[40:41], v4, s[48:51], s10 offen offset:0 sc1
    buffer_load_dwordx2 v[42:43], v4, s[48:51], s10 offen offset:2048 sc1
    s_add_u32 s10, s10, 0x1000
    buffer_load_dwordx2 v[44:45], v4, s[48:51], s10 offen offset:0 sc1
    buffer_load_dwordx2 v[46:47], v4, s[48:51], s10 offen offset:2048 sc1
    s_add_u32 s10, s10, 0x1000
    s_add_u32 s76, s76, 1
    v_mov_b32 v2, 0
    v_mov_b32 v3, 0
    s_waitcnt vmcnt(0)
    v_xor_b32 v17, s9, v17
    v_max_u32 v2, v2, v16
    v_or_b32 v3, v3, v17
    v_xor_b32 v19, s9, v19
    v_max_u32 v2, v2, v18
    v_or_b32 v3, v3, v19
    v_xor_b32 v21, s9, v21
    v_max_u32 v2, v2, v20
    v_or_b32 v3, v3, v21
    v_xor_b32 v23, s9, v23
    v_max_u32 v2, v2, v22
    v_or_b32 v3, v3, v23
    v_xor_b32 v25, s9, v25
    v_max_u32 v2, v2, v24
    v_or_b32 v3, v3, v25
    v_xor_b32 v27, s9, v27
    v_max_u32 v2, v2, v26
    v_or_b32 v3, v3, v27
    v_xor_b32 v29, s9, v29
    v_max_u32 v2, v2, v28
    v_or_b32 v3, v3, v29
    v_xor_b32 v31, s9, v31
    v_max_u32 v2, v2, v30
    v_or_b32 v3, v3, v31
    v_xor_b32 v33, s9, v33
    v_max_u32 v2, v2, v32
    v_or_b32 v3, v3, v33
    v_xor_b32 v35, s9, v35
    v_max_u32 v2, v2, v34
    v_or_b32 v3, v3, v35
    v_xor_b32 v37, s9, v37
    v_max_u32 v2, v2, v36
    v_or_b32 v3, v3, v37
    v_xor_b32 v39, s9, v39
    v_max_u32 v2, v2, v38
    v_or_b32 v3, v3, v39
    v_xor_b32 v41, s9, v41
    v_max_u32 v2, v2, v40
    v_or_b32 v3, v3, v41
    v_xor_b32 v43, s9, v43
    v_max_u32 v2, v2, v42
    v_or_b32 v3, v3, v43
    v_xor_b32 v45, s9, v45
    v_max_u32 v2, v2, v44
    v_or_b32 v3, v3, v45
    v_xor_b32 v47, s9, v47
    v_max_u32 v2, v2, v46
    v_or_b32 v3, v3, v47
    v_cmp_ne_u32 vcc, 0, v3
    s_cbranch_vccz L_keysok
    s_sleep 16
    s_cmp_lt_u32 s76, 40000
    s_cbranch_scc1 L_keys
L_keysok:
    s_nop 1
    v_max_u32_dpp v2, v2, v2 quad_perm:[1,0,3,2] row_mask:0xf bank_mask:0xf
    s_nop 1
    v_max_u32_dpp v2, v2, v2 quad_perm:[2,3,0,1] row_mask:0xf bank_mask:0xf
    s_nop 1
    v_max_u32_dpp v2, v2, v2 row_half_mirror row_mask:0xf bank_mask:0xf
    s_nop 1
    v_max_u32_dpp v2, v2, v2 row_mirror row_mask:0xf bank_mask:0xf
    s_nop 1
    v_max_u32_dpp v2, v2, v2 row_bcast:15 row_mask:0xa bank_mask:0xf
    s_nop 1
    v_max_u32_dpp v2, v2, v2 row_bcast:31 row_mask:0xc bank_mask:0xf
    s_nop 0
    v_readlane_b32 s10, v2, 63
    v_mov_b32 v3, s9
    s_mov_b32 s11, 0x834000
    v_mov_b32 v2, s10
    s_mov_b64 exec, 0xff
    buffer_store_dwordx2 v[2:3], v151, s[48:51], s11 offen sc1
    s_mov_b64 exec, -1
    s_branch L_outproj
L_moeA:
    s_mov_b64 s[52:53], s[26:27]
    s_mov_b32 s54, 0x158000
    s_mov_b32 s55, 0x20000
    s_mov_b64 s[56:57], s[28:29]
    s_mov_b32 s58, 0x158000
    s_mov_b32 s59, 0x20000
    s_mul_i32 s60, s2, 1525
    s_lshr_b32 s60, s60, 16
    s_mul_i32 s11, s60, 43
    s_sub_u32 s61, s2, s11
    v_mul_u32_u24 v2, 2752, v7
    v_add_u32 v2, v2, v8
    s_mul_i32 s10, s60, 352256
    s_lshl_b32 s11, s61, 6
    s_add_u32 s10, s10, s11
    s_mov_b32 s11, 122880
    s_mov_b32 s12, 8
L_dmagu:
    s_mov_b32 m0, s11
    s_sub_u32 s12, s12, 1
    buffer_load_dwordx4 v2, s[52:55], s10 offen lds
    s_add_u32 m0, s11, 0x2000
    s_add_u32 s11, s11, 0x400
    buffer_load_dwordx4 v2, s[56:59], s10 offen lds
    s_add_u32 s10, s10, 44032
    s_waitcnt vmcnt(2)
    s_cmp_lg_u32 s12, 0
    s_cbranch_scc1 L_dmagu
    s_mov_b32 s76, 0
L_selA:
    buffer_load_dwordx2 v[2:3], v155, s[48:51], 0 offen sc1
    s_add_u32 s76, s76, 1
    s_waitcnt vmcnt(0)
    v_cmp_ne_u32 vcc, s9, v3
    s_cbranch_vccz L_selAok
    s_sleep 8
    s_cmp_lt_u32 s76, 40000
    s_cbranch_scc1 L_selA
L_selAok:
    v_readfirstlane_b32 s10, v2
    v_lshlrev_b32 v4, 4, v147
    v_lshl_add_u32 v140, v156, 6, v157
    v_add_u32 v140, 122880, v140
    s_and_b32 s10, s10, 0x7ff
    s_sub_u32 s10, 2047, s10
    s_lshl_b32 s10, s10, 10
    s_lshl_b32 s11, s60, 8
    s_add_u32 s10, s10, s11
    buffer_load_dwordx4 v[32:35], v4, s[40:43], s10 offen offset:0
    buffer_load_dwordx4 v[36:39], v4, s[40:43], s10 offen offset:32
    buffer_load_dwordx4 v[40:43], v4, s[40:43], s10 offen offset:64
    buffer_load_dwordx4 v[44:47], v4, s[40:43], s10 offen offset:96
    buffer_load_dwordx4 v[48:51], v4, s[40:43], s10 offen offset:128
    buffer_load_dwordx4 v[52:55], v4, s[40:43], s10 offen offset:160
    buffer_load_dwordx4 v[56:59], v4, s[40:43], s10 offen offset:192
    buffer_load_dwordx4 v[60:63], v4, s[40:43], s10 offen offset:224
    ds_read_b64_tr_b16 v[64:65], v140 offset:0
    ds_read_b64_tr_b16 v[66:67], v140 offset:256
    ds_read_b64_tr_b16 v[68:69], v140 offset:8192
    ds_read_b64_tr_b16 v[70:71], v140 offset:8448
    s_waitcnt vmcnt(0) lgkmcnt(0)
    v_mfma_f32_32x32x16_bf16 v[0:15], v[32:35], v[64:67], 0
    ds_read_b64_tr_b16 v[72:73], v140 offset:1024
    ds_read_b64_tr_b16 v[74:75], v140 offset:1280
    ds_read_b64_tr_b16 v[76:77], v140 offset:9216
    ds_read_b64_tr_b16 v[78:79], v140 offset:9472
    s_waitcnt lgkmcnt(0)
    v_mfma_f32_32x32x16_bf16 v[16:31], v[32:35], v[68:71], 0
    v_mfma_f32_32x32x16_bf16 v[0:15], v[36:39], v[72:75], v[0:15]
    ds_read_b64_tr_b16 v[80:81], v140 offset:2048
    ds_read_b64_tr_b16 v[82:83], v140 offset:2304
    ds_read_b64_tr_b16 v[84:85], v140 offset:10240
    ds_read_b64_tr_b16 v[86:87], v140 offset:10496
    s_waitcnt lgkmcnt(0)
    v_mfma_f32_32x32x16_bf16 v[16:31], v[36:39], v[76:79], v[16:31]
    v_mfma_f32_32x32x16_bf16 v[0:15], v[40:43], v[80:83], v[0:15]
    ds_read_b64_tr_b16 v[88:89], v140 offset:3072
    ds_read_b64_tr_b16 v[90:91], v140 offset:3328
    ds_read_b64_tr_b16 v[92:93], v140 offset:11264
    ds_read_b64_tr_b16 v[94:95], v140 offset:11520
    s_waitcnt lgkmcnt(0)
    v_mfma_f32_32x32x16_bf16 v[16:31], v[40:43], v[84:87], v[16:31]
    v_mfma_f32_32x32x16_bf16 v[0:15], v[44:47], v[88:91], v[0:15]
    ds_read_b64_tr_b16 v[96:97], v140 offset:4096
    ds_read_b64_tr_b16 v[98:99], v140 offset:4352
    ds_read_b64_tr_b16 v[100:101], v140 offset:12288
    ds_read_b64_tr_b16 v[102:103], v140 offset:12544
    s_waitcnt lgkmcnt(0)
    v_mfma_f32_32x32x16_bf16 v[16:31], v[44:47], v[92:95], v[16:31]
    v_mfma_f32_32x32x16_bf16 v[0:15], v[48:51], v[96:99], v[0:15]
    ds_read_b64_tr_b16 v[104:105], v140 offset:5120
    ds_read_b64_tr_b16 v[106:107], v140 offset:5376
    ds_read_b64_tr_b16 v[108:109], v140 offset:13312
    ds_read_b64_tr_b16 v[110:111], v140 offset:13568
    s_waitcnt lgkmcnt(0)
    v_mfma_f32_32x32x16_bf16 v[16:31], v[48:51], v[100:103], v[16:31]
    v_mfma_f32_32x32x16_bf16 v[0:15], v[52:55], v[104:107], v[0:15]
    ds_read_b64_tr_b16 v[112:113], v140 offset:6144
    ds_read_b64_tr_b16 v[114:115], v140 offset:6400
    ds_read_b64_tr_b16 v[116:117], v140 offset:14336
    ds_read_b64_tr_b16 v[118:119], v140 offset:14592
    s_waitcnt lgkmcnt(0)
    v_mfma_f32_32x32x16_bf16 v[16:31], v[52:55], v[108:111], v[16:31]
    v_mfma_f32_32x32x16_bf16 v[0:15], v[56:59], v[112:115], v[0:15]
    ds_read_b64_tr_b16 v[120:121], v140 offset:7168
    ds_read_b64_tr_b16 v[122:123], v140 offset:7424
    ds_read_b64_tr_b16 v[124:125], v140 offset:15360
    ds_read_b64_tr_b16 v[126:127], v140 offset:15616
    s_waitcnt lgkmcnt(0)
    v_mfma_f32_32x32x16_bf16 v[16:31], v[56:59], v[116:119], v[16:31]
    v_mfma_f32_32x32x16_bf16 v[0:15], v[60:63], v[120:123], v[0:15]
    v_mfma_f32_32x32x16_bf16 v[16:31], v[60:63], v[124:127], v[16:31]
    v_cmp_gt_u32 vcc, 32, v159
    s_lshl_b32 s10, s61, 2
    s_add_u32 s10, s10, s60
    s_lshl_b32 s10, s10, 9
    s_add_u32 s10, s10, 0x868000
    v_mov_b32 v33, s9
    s_nop 7
    v_cndmask_b32 v32, v16, v0, vcc
    buffer_store_dwordx2 v[32:33], v153, s[48:51], s10 offen sc1
    s_branch L_outproj
L_moeB:
    s_mov_b64 s[52:53], s[30:31]
    s_mov_b32 s54, 0x158000
    s_mov_b32 s55, 0x20000
    s_sub_u32 s61, s2, 172
    v_lshrrev_b32 v2, 4, v159
    v_and_b32 v4, 0xf0, v163
    v_lshl_add_u32 v2, v2, 10, v4
    s_lshl_b32 s10, s61, 15
    s_lshl_b32 s11, s3, 8
    s_add_u32 s10, s10, s11
    s_lshl_b32 s60, s3, 13
    s_add_u32 s60, s60, 122880
    s_mov_b32 s11, s60
    s_mov_b32 s12, 8
L_dmawd:
    s_mov_b32 m0, s11
    s_add_u32 s11, s11, 0x400
    buffer_load_dwordx4 v2, s[52:55], s10 offen lds
    s_add_u32 s10, s10, 0x1000
    s_sub_u32 s12, s12, 1
    s_waitcnt vmcnt(2)
    s_cmp_lg_u32 s12, 0
    s_cbranch_scc1 L_dmawd
    v_lshl_add_u32 v42, v156, 8, v157
    v_add_u32 v42, s60, v42
    s_waitcnt vmcnt(0)
    ds_read_b64_tr_b16 v[80:81], v42 offset:0
    ds_read_b64_tr_b16 v[82:83], v42 offset:1024
    ds_read_b64_tr_b16 v[84:85], v42 offset:4096
    ds_read_b64_tr_b16 v[86:87], v42 offset:5120
    ds_read_b64_tr_b16 v[88:89], v42 offset:64
    ds_read_b64_tr_b16 v[90:91], v42 offset:1088
    ds_read_b64_tr_b16 v[92:93], v42 offset:4160
    ds_read_b64_tr_b16 v[94:95], v42 offset:5184
    ds_read_b64_tr_b16 v[96:97], v42 offset:128
    ds_read_b64_tr_b16 v[98:99], v42 offset:1152
    ds_read_b64_tr_b16 v[100:101], v42 offset:4224
    ds_read_b64_tr_b16 v[102:103], v42 offset:5248
    ds_read_b64_tr_b16 v[104:105], v42 offset:192
    ds_read_b64_tr_b16 v[106:107], v42 offset:1216
    ds_read_b64_tr_b16 v[108:109], v42 offset:4288
    ds_read_b64_tr_b16 v[110:111], v42 offset:5312
    s_lshl_b32 s10, s61, 11
    s_add_u32 s10, s10, 0x868000
    s_mov_b32 s76, 0
L_pa:
    buffer_load_dwordx2 v[0:1], v153, s[48:51], s10 offen offset:0 sc1
    buffer_load_dwordx2 v[2:3], v153, s[48:51], s10 offen offset:512 sc1
    buffer_load_dwordx2 v[4:5], v153, s[48:51], s10 offen offset:1024 sc1
    buffer_load_dwordx2 v[6:7], v153, s[48:51], s10 offen offset:1536 sc1
    s_add_u32 s76, s76, 1
    s_waitcnt vmcnt(0)
    v_xor_b32 v1, s9, v1
    v_xor_b32 v3, s9, v3
    v_xor_b32 v5, s9, v5
    v_xor_b32 v7, s9, v7
    v_or3_b32 v1, v1, v3, v5
    v_or_b32 v1, v1, v7
    v_cmp_ne_u32 vcc, 0, v1
    s_cbranch_vccz L_paok
    s_sleep 16
    s_cmp_lt_u32 s76, 40000
    s_cbranch_scc1 L_pa
L_paok:
    v_add_f32 v0, v0, v2
    v_add_f32 v4, v4, v6
    v_add_f32 v0, v0, v4
    v_mov_b32 v1, v0
    s_nop 1
    v_permlane32_swap_b32 v0, v1
    s_nop 1
    v_cvt_pk_bf16_f32 v2, v0, v1
    s_mov_b32 s11, 0x3fb8aa3b
    v_lshlrev_b32 v0, 16, v2
    v_and_b32 v1, 0xffff0000, v2
    v_mul_f32 v3, s11, v0
    v_exp_f32 v3, -v3
    s_nop 0
    v_add_f32 v3, 1.0, v3
    v_rcp_f32 v3, v3
    s_nop 0
    v_mul_f32 v3, v0, v3
    v_cvt_pk_bf16_f32 v3, v3, v3
    v_lshlrev_b32 v3, 16, v3
    v_mul_f32 v3, v3, v1
    v_cvt_pk_bf16_f32 v3, v3, v3
    s_lshl_b32 s11, s3, 10
    s_add_u32 s11, s11, 155648
    v_lshl_add_u32 v2, v146, 1, s11
    ds_write_b16 v2, v3
    v_lshl_add_u32 v2, v147, 4, s11
    s_waitcnt lgkmcnt(0)
    ds_read_b128 v[112:115], v2
    ds_read_b128 v[116:119], v2 offset:32
    v_cmp_gt_u32 vcc, 32, v159
    v_mov_b32 v121, s9
    v_mov_b32 v123, s9
    s_lshl_b32 s10, s61, 12
    s_lshl_b32 s11, s3, 10
    s_add_u32 s10, s10, s11
    s_add_u32 s10, s10, 0x838000
    s_waitcnt lgkmcnt(0)
    v_mfma_f32_32x32x16_bf16 v[16:31], v[112:115], v[80:83], 0
    v_mfma_f32_32x32x16_bf16 v[32:47], v[112:115], v[88:91], 0
    v_mfma_f32_32x32x16_bf16 v[48:63], v[112:115], v[96:99], 0
    v_mfma_f32_32x32x16_bf16 v[64:79], v[112:115], v[104:107], 0
    v_mfma_f32_32x32x16_bf16 v[16:31], v[116:119], v[84:87], v[16:31]
    v_mfma_f32_32x32x16_bf16 v[32:47], v[116:119], v[92:95], v[32:47]
    v_mfma_f32_32x32x16_bf16 v[48:63], v[116:119], v[100:103], v[48:63]
    v_mfma_f32_32x32x16_bf16 v[64:79], v[116:119], v[108:111], v[64:79]
    s_nop 12
    v_cndmask_b32 v120, v32, v16, vcc
    v_cndmask_b32 v122, v64, v48, vcc
    buffer_store_dwordx2 v[120:121], v153, s[48:51], s10 offen sc1
    buffer_store_dwordx2 v[122:123], v153, s[48:51], s10 offen offset:512 sc1
    s_cmp_lt_u32 s3, 2
    s_cbranch_scc1 L_wo
L_outproj:
    v_mov_b32 v24, 1
    s_mov_b64 exec, 1
    ds_write_b32 v165, v24 offset:112
    s_mov_b64 exec, -1
    s_mov_b32 s76, 0
lw_15:
    ds_read_b32 v164, v166 offset:112
    s_add_u32 s76, s76, 1
    s_waitcnt lgkmcnt(0)
    v_cmp_gt_u32 vcc, 1, v164
    s_cbranch_vccz lwd_16
    s_sleep 8
    s_cmp_lt_u32 s76, 0x40000
    s_cbranch_scc1 lw_15
lwd_16:
    buffer_load_dwordx4 v[128:131], v150, s[40:43], s92 offen
    buffer_load_dwordx4 v[132:135], v150, s[40:43], s92 offen offset:32
    s_lshl_b32 s10, s7, 11
    s_add_u32 s63, s10, s93
    v_lshl_add_u32 v3, v159, 7, s63
    s_lshl_b32 s10, s7, 8
    s_add_u32 s64, s10, s94
    s_add_u32 s10, s64, 128
    v_writelane_b32 v3, s64, 16
    v_writelane_b32 v3, s10, 17
    s_mov_b64 exec, 0x3ffff
    buffer_load_dword v5, v3, s[48:51], 0 offen sc1
    s_mov_b64 exec, -1
    s_mov_b32 s76, 0
L_gsel:
    buffer_load_dwordx2 v[136:137], v154, s[48:51], 0 offen sc1
    buffer_load_dwordx2 v[138:139], v155, s[48:51], 0 offen sc1
    s_add_u32 s76, s76, 1
    s_waitcnt vmcnt(0) lgkmcnt(0)
    v_cmp_ne_u32 vcc, s9, v137
    v_cmp_ne_u32 s[12:13], s9, v139
    s_or_b64 vcc, vcc, s[12:13]
    s_cbranch_vccz L_gselok
    s_sleep 32
    s_cmp_lt_u32 s76, 40000
    s_cbranch_scc1 L_gsel
L_gselok:
    v_readfirstlane_b32 s60, v138
    v_and_b32 v4, 1, v159
    v_cmp_eq_u32 vcc, 1, v4
    v_lshlrev_b32 v144, 16, v136
    v_and_b32 v145, 0xffff0000, v136
    v_cndmask_b32 v144, v144, v145, vcc
    v_sub_f32 v136, 1.0, v144
    v_cvt_pk_bf16_f32 v136, v136, v136
    v_and_b32 v136, 0xffff0000, v136
    v_lshlrev_b32 v112, 16, v128
    v_and_b32 v113, 0xffff0000, v128
    v_lshlrev_b32 v114, 16, v129
    v_and_b32 v115, 0xffff0000, v129
    v_lshlrev_b32 v116, 16, v130
    v_and_b32 v117, 0xffff0000, v130
    v_lshlrev_b32 v118, 16, v131
    v_and_b32 v119, 0xffff0000, v131
    v_lshlrev_b32 v120, 16, v132
    v_and_b32 v121, 0xffff0000, v132
    v_lshlrev_b32 v122, 16, v133
    v_and_b32 v123, 0xffff0000, v133
    v_lshlrev_b32 v124, 16, v134
    v_and_b32 v125, 0xffff0000, v134
    v_lshlrev_b32 v126, 16, v135
    v_and_b32 v127, 0xffff0000, v135
    s_and_b32 s10, s60, 0x7ff
    s_sub_u32 s14, 2047, s10
    s_lshr_b32 s10, s14, 5
    s_cmp_lg_u32 s10, s68
    s_cbranch_scc1 L_noupd
    s_lshl_b32 s13, s7, 8
    s_add_u32 s13, s13, 0x838000
    v_mul_u32_u24 v140, 86016, v147
    v_lshl_add_u32 v140, v146, 3, v140
    v_min_u32 v141, 42, v159
    v_lshlrev_b32 v141, 12, v141
    v_add_u32 v141, 4, v141
    s_mov_b32 s76, 0
poll_17:
    buffer_load_dword v164, v141, s[48:51], s13 offen sc1
    s_add_u32 s76, s76, 1
    s_waitcnt vmcnt(0)
    v_cmp_ne_u32 vcc, s9, v164
    s_cbranch_vccz polldone_18
    s_sleep 32
    s_cmp_lt_u32 s76, 40000
    s_cbranch_scc1 poll_17
polldone_18:
    s_mov_b32 s76, 0
L_ypoll:
    s_mov_b32 s10, s13
    buffer_load_dwordx2 v[16:17], v140, s[48:51], s10 offen sc1
    s_add_u32 s10, s10, 0x1000
    buffer_load_dwordx2 v[18:19], v140, s[48:51], s10 offen sc1
    s_add_u32 s10, s10, 0x1000
    buffer_load_dwordx2 v[20:21], v140, s[48:51], s10 offen sc1
    s_add_u32 s10, s10, 0x1000
    buffer_load_dwordx2 v[22:23], v140, s[48:51], s10 offen sc1
    s_add_u32 s10, s10, 0x1000
    buffer_load_dwordx2 v[24:25], v140, s[48:51], s10 offen sc1
    s_add_u32 s10, s10, 0x1000
    buffer_load_dwordx2 v[26:27], v140, s[48:51], s10 offen sc1
    s_add_u32 s10, s10, 0x1000
    buffer_load_dwordx2 v[28:29], v140, s[48:51], s10 offen sc1
    s_add_u32 s10, s10, 0x1000
    buffer_load_dwordx2 v[30:31], v140, s[48:51], s10 offen sc1
    s_add_u32 s10, s10, 0x1000
    buffer_load_dwordx2 v[32:33], v140, s[48:51], s10 offen sc1
    s_add_u32 s10, s10, 0x1000
    buffer_load_dwordx2 v[34:35], v140, s[48:51], s10 offen sc1
    s_add_u32 s10, s10, 0x1000
    buffer_load_dwordx2 v[36:37], v140, s[48:51], s10 offen sc1
    s_add_u32 s10, s10, 0x1000
    buffer_load_dwordx2 v[38:39], v140, s[48:51], s10 offen sc1
    s_add_u32 s10, s10, 0x1000
    buffer_load_dwordx2 v[40:41], v140, s[48:51], s10 offen sc1
    s_add_u32 s10, s10, 0x1000
    buffer_load_dwordx2 v[42:43], v140, s[48:51], s10 offen sc1
    s_add_u32 s10, s10, 0x1000
    buffer_load_dwordx2 v[44:45], v140, s[48:51], s10 offen sc1
    s_add_u32 s10, s10, 0x1000
    buffer_load_dwordx2 v[46:47], v140, s[48:51], s10 offen sc1
    s_add_u32 s10, s10, 0x1000
    buffer_load_dwordx2 v[48:49], v140, s[48:51], s10 offen sc1
    s_add_u32 s10, s10, 0x1000
    buffer_load_dwordx2 v[50:51], v140, s[48:51], s10 offen sc1
    s_add_u32 s10, s10, 0x1000
    buffer_load_dwordx2 v[52:53], v140, s[48:51], s10 offen sc1
    s_add_u32 s10, s10, 0x1000
    buffer_load_dwordx2 v[54:55], v140, s[48:51], s10 offen sc1
    s_add_u32 s10, s10, 0x1000
    buffer_load_dwordx2 v[56:57], v140, s[48:51], s10 offen sc1
    s_add_u32 s10, s10, 0x1000
    buffer_load_dwordx2 v[58:59], v140, s[48:51], s10 offen sc1
    s_add_u32 s10, s10, 0x1000
    s_add_u32 s76, s76, 1
    v_mov_b32 v141, 0
    s_waitcnt vmcnt(0)
    v_xor_b32 v17, s9, v17
    v_or_b32 v141, v141, v17
    v_xor_b32 v19, s9, v19
    v_or_b32 v141, v141, v19
    v_xor_b32 v21, s9, v21
    v_or_b32 v141, v141, v21
    v_xor_b32 v23, s9, v23
    v_or_b32 v141, v141, v23
    v_xor_b32 v25, s9, v25
    v_or_b32 v141, v141, v25
    v_xor_b32 v27, s9, v27
    v_or_b32 v141, v141, v27
    v_xor_b32 v29, s9, v29
    v_or_b32 v141, v141, v29
    v_xor_b32 v31, s9, v31
    v_or_b32 v141, v141, v31
    v_xor_b32 v33, s9, v33
    v_or_b32 v141, v141, v33
    v_xor_b32 v35, s9, v35
    v_or_b32 v141, v141, v35
    v_xor_b32 v37, s9, v37
    v_or_b32 v141, v141, v37
    v_xor_b32 v39, s9, v39
    v_or_b32 v141, v141, v39
    v_xor_b32 v41, s9, v41
    v_or_b32 v141, v141, v41
    v_xor_b32 v43, s9, v43
    v_or_b32 v141, v141, v43
    v_xor_b32 v45, s9, v45
    v_or_b32 v141, v141, v45
    v_xor_b32 v47, s9, v47
    v_or_b32 v141, v141, v47
    v_xor_b32 v49, s9, v49
    v_or_b32 v141, v141, v49
    v_xor_b32 v51, s9, v51
    v_or_b32 v141, v141, v51
    v_xor_b32 v53, s9, v53
    v_or_b32 v141, v141, v53
    v_xor_b32 v55, s9, v55
    v_or_b32 v141, v141, v55
    v_xor_b32 v57, s9, v57
    v_or_b32 v141, v141, v57
    v_xor_b32 v59, s9, v59
    v_or_b32 v141, v141, v59
    v_cmp_ne_u32 vcc, 0, v141
    s_cbranch_vccz L_yok
    s_sleep 32
    s_cmp_lt_u32 s76, 40000
    s_cbranch_scc1 L_ypoll
L_yok:
    v_cmp_gt_u32 vcc, 32, v159
    s_nop 1
    v_cndmask_b32 v16, 0, v16, vcc
    v_add_f32 v16, v16, v18
    v_add_f32 v16, v16, v20
    v_add_f32 v16, v16, v22
    v_add_f32 v16, v16, v24
    v_add_f32 v16, v16, v26
    v_add_f32 v16, v16, v28
    v_add_f32 v16, v16, v30
    v_add_f32 v16, v16, v32
    v_add_f32 v16, v16, v34
    v_add_f32 v16, v16, v36
    v_add_f32 v16, v16, v38
    v_add_f32 v16, v16, v40
    v_add_f32 v16, v16, v42
    v_add_f32 v16, v16, v44
    v_add_f32 v16, v16, v46
    v_add_f32 v16, v16, v48
    v_add_f32 v16, v16, v50
    v_add_f32 v16, v16, v52
    v_add_f32 v16, v16, v54
    v_add_f32 v16, v16, v56
    v_add_f32 v16, v16, v58
    v_mov_b32 v17, v16
    s_and_b32 s10, s60, 0xffff0000
    s_ashr_i32 s11, s10, 31
    v_permlane32_swap_b32 v16, v17
    s_not_b32 s11, s11
    s_or_b32 s11, s11, 0x80000000
    s_xor_b32 s10, s10, s11
    s_and_b32 s10, s10, 0xffff0000
    v_mov_b32 v24, 0x3fb8aa3b
    v_mul_f32 v24, s10, v24
    v_exp_f32 v24, -v24
    v_add_f32 v20, v16, v17
    v_add_f32 v24, 1.0, v24
    v_rcp_f32 v24, v24
    v_cvt_pk_bf16_f32 v20, v20, v20
    v_cvt_pk_bf16_f32 v24, v24, v24
    v_and_b32 v24, 0xffff0000, v24
    v_and_b32 v20, 0xffff0000, v20
    v_mul_f32 v20, v20, v24
    v_cvt_pk_bf16_f32 v20, v20, v20
    v_and_b32 v20, 0xffff0000, v20
    s_lshl_b32 s11, s3, 10
    s_add_u32 s11, s11, 155648
    v_lshl_add_u32 v21, v146, 2, s11
    v_lshl_add_u32 v141, v147, 5, s11
    ds_write_b32 v21, v20
    s_waitcnt lgkmcnt(0)
    ds_read_b128 v[16:19], v141
    ds_read_b128 v[20:23], v141 offset:16
    ds_read_b128 v[24:27], v141 offset:64
    ds_read_b128 v[28:31], v141 offset:80
    s_and_b32 s10, s14, 31
    v_cmp_eq_u32 vcc, s10, v146
    s_nop 0
    s_waitcnt lgkmcnt(0)
    v_cndmask_b32 v16, 0, v16, vcc
    v_add_f32 v112, v112, v16
    v_cndmask_b32 v17, 0, v17, vcc
    v_add_f32 v113, v113, v17
    v_cndmask_b32 v18, 0, v18, vcc
    v_add_f32 v114, v114, v18
    v_cndmask_b32 v19, 0, v19, vcc
    v_add_f32 v115, v115, v19
    v_cndmask_b32 v20, 0, v20, vcc
    v_add_f32 v116, v116, v20
    v_cndmask_b32 v21, 0, v21, vcc
    v_add_f32 v117, v117, v21
    v_cndmask_b32 v22, 0, v22, vcc
    v_add_f32 v118, v118, v22
    v_cndmask_b32 v23, 0, v23, vcc
    v_add_f32 v119, v119, v23
    v_cndmask_b32 v24, 0, v24, vcc
    v_add_f32 v120, v120, v24
    v_cndmask_b32 v25, 0, v25, vcc
    v_add_f32 v121, v121, v25
    v_cndmask_b32 v26, 0, v26, vcc
    v_add_f32 v122, v122, v26
    v_cndmask_b32 v27, 0, v27, vcc
    v_add_f32 v123, v123, v27
    v_cndmask_b32 v28, 0, v28, vcc
    v_add_f32 v124, v124, v28
    v_cndmask_b32 v29, 0, v29, vcc
    v_add_f32 v125, v125, v29
    v_cndmask_b32 v30, 0, v30, vcc
    v_add_f32 v126, v126, v30
    v_cndmask_b32 v31, 0, v31, vcc
    v_add_f32 v127, v127, v31
    v_cvt_pk_bf16_f32 v16, v112, v113
    v_cvt_pk_bf16_f32 v17, v114, v115
    v_cvt_pk_bf16_f32 v18, v116, v117
    v_cvt_pk_bf16_f32 v19, v118, v119
    v_cvt_pk_bf16_f32 v20, v120, v121
    v_cvt_pk_bf16_f32 v21, v122, v123
    v_cvt_pk_bf16_f32 v22, v124, v125
    v_cvt_pk_bf16_f32 v23, v126, v127
    v_lshlrev_b32 v112, 16, v16
    v_and_b32 v113, 0xffff0000, v16
    v_lshlrev_b32 v114, 16, v17
    v_and_b32 v115, 0xffff0000, v17
    v_lshlrev_b32 v116, 16, v18
    v_and_b32 v117, 0xffff0000, v18
    v_lshlrev_b32 v118, 16, v19
    v_and_b32 v119, 0xffff0000, v19
    v_lshlrev_b32 v120, 16, v20
    v_and_b32 v121, 0xffff0000, v20
    v_lshlrev_b32 v122, 16, v21
    v_and_b32 v123, 0xffff0000, v21
    v_lshlrev_b32 v124, 16, v22
    v_and_b32 v125, 0xffff0000, v22
    v_lshlrev_b32 v126, 16, v23
    v_and_b32 v127, 0xffff0000, v23
L_noupd:
    s_mov_b32 s76, 0
lw_19:
    ds_read_b32 v164, v166 offset:16
    s_add_u32 s76, s76, 1
    s_waitcnt lgkmcnt(0)
    v_cmp_gt_u32 vcc, 12, v164
    s_cbranch_vccz lwd_20
    s_sleep 8
    s_cmp_lt_u32 s76, 0x40000
    s_cbranch_scc1 lw_19
lwd_20:
    v_mov_b32 v160, v144
    v_mov_b32 v161, v149
    v_mov_b32 v165, v150
    v_mov_b32 v166, v151
    v_pk_mul_f32 v[144:145], v[112:113], v[136:137] op_sel_hi:[1,0]
    v_pk_mul_f32 v[146:147], v[114:115], v[136:137] op_sel_hi:[1,0]
    v_pk_mul_f32 v[148:149], v[116:117], v[136:137] op_sel_hi:[1,0]
    v_pk_mul_f32 v[150:151], v[118:119], v[136:137] op_sel_hi:[1,0]
    v_pk_mul_f32 v[152:153], v[120:121], v[136:137] op_sel_hi:[1,0]
    v_pk_mul_f32 v[154:155], v[122:123], v[136:137] op_sel_hi:[1,0]
    v_pk_mul_f32 v[156:157], v[124:125], v[136:137] op_sel_hi:[1,0]
    v_pk_mul_f32 v[158:159], v[126:127], v[136:137] op_sel_hi:[1,0]
    v_mov_b64 v[0:1], 0
    v_mov_b64 v[2:3], 0
    v_mov_b64 v[4:5], 0
    v_mov_b64 v[6:7], 0
    v_mov_b64 v[8:9], 0
    v_mov_b64 v[10:11], 0
    v_mov_b64 v[12:13], 0
    v_mov_b64 v[14:15], 0
    s_mov_b64 s[52:53], s[34:35]
    s_mov_b32 s54, 0x200000
    s_mov_b32 s55, 0x20000
    s_mov_b32 s88, 0
    v_mov_b32 v164, 0
    s_mov_b32 s69, 0
    s_mov_b32 s95, 0
L_ev:
    s_not_b32 exec_lo, s69
    s_mov_b32 exec_hi, 0
    buffer_load_dword v164, v166, s[48:51], s94 offen sc1
    s_mov_b64 exec, -1
L_ev2:
    s_add_u32 s95, s95, 1
    s_waitcnt vmcnt(0)
    v_cmp_eq_u32 vcc, s9, v164
    s_andn2_b32 s61, vcc_lo, s69
    s_bcnt1_i32_b32 s60, s61
    s_cbranch_scc0 L_more
    s_cmp_ge_u32 s60, 9
    s_cbranch_scc1 tr_21
    s_cmp_ge_u32 s60, 5
    s_cbranch_scc1 tr_22
    s_cmp_ge_u32 s60, 3
    s_cbranch_scc1 tr_23
    s_cmp_lt_u32 s60, 2
    s_cbranch_scc1 L_is15
    s_branch L_is14
tr_23:
    s_cmp_lt_u32 s60, 4
    s_cbranch_scc1 L_is13
    s_branch L_is12
tr_22:
    s_cmp_ge_u32 s60, 7
    s_cbranch_scc1 tr_24
    s_cmp_lt_u32 s60, 6
    s_cbranch_scc1 L_is11
    s_branch L_is10
tr_24:
    s_cmp_lt_u32 s60, 8
    s_cbranch_scc1 L_is9
    s_branch L_is8
tr_21:
    s_cmp_ge_u32 s60, 13
    s_cbranch_scc1 tr_25
    s_cmp_ge_u32 s60, 11
    s_cbranch_scc1 tr_26
    s_cmp_lt_u32 s60, 10
    s_cbranch_scc1 L_is7
    s_branch L_is6
tr_26:
    s_cmp_lt_u32 s60, 12
    s_cbranch_scc1 L_is5
    s_branch L_is4
tr_25:
    s_cmp_ge_u32 s60, 15
    s_cbranch_scc1 tr_27
    s_cmp_lt_u32 s60, 14
    s_cbranch_scc1 L_is3
    s_branch L_is2
tr_27:
    s_cmp_lt_u32 s60, 16
    s_cbranch_scc1 L_is1
L_is0:
    s_ff1_i32_b32 s10, s61
    s_bitset0_b32 s61, s10
    s_bitset1_b32 s69, s10
    s_lshl_b32 s10, s10, 10
    s_add_u32 s11, s10, s93
    v_add_u32 v162, s10, v161
    buffer_load_dwordx4 v[16:19], v163, s[48:51], s11 offen sc1
    ds_read_b64_tr_b16 v[80:81], v162
    ds_read_b64_tr_b16 v[82:83], v162 offset:512
L_is1:
    s_ff1_i32_b32 s10, s61
    s_bitset0_b32 s61, s10
    s_bitset1_b32 s69, s10
    s_lshl_b32 s10, s10, 10
    s_add_u32 s11, s10, s93
    v_add_u32 v162, s10, v161
    buffer_load_dwordx4 v[20:23], v163, s[48:51], s11 offen sc1
    ds_read_b64_tr_b16 v[84:85], v162
    ds_read_b64_tr_b16 v[86:87], v162 offset:512
L_is2:
    s_ff1_i32_b32 s10, s61
    s_bitset0_b32 s61, s10
    s_bitset1_b32 s69, s10
    s_lshl_b32 s10, s10, 10
    s_add_u32 s11, s10, s93
    v_add_u32 v162, s10, v161
    buffer_load_dwordx4 v[24:27], v163, s[48:51], s11 offen sc1
    ds_read_b64_tr_b16 v[88:89], v162
    ds_read_b64_tr_b16 v[90:91], v162 offset:512
L_is3:
    s_ff1_i32_b32 s10, s61
    s_bitset0_b32 s61, s10
    s_bitset1_b32 s69, s10
    s_lshl_b32 s10, s10, 10
    s_add_u32 s11, s10, s93
    v_add_u32 v162, s10, v161
    buffer_load_dwordx4 v[28:31], v163, s[48:51], s11 offen sc1
    ds_read_b64_tr_b16 v[92:93], v162
    ds_read_b64_tr_b16 v[94:95], v162 offset:512
L_is4:
    s_ff1_i32_b32 s10, s61
    s_bitset0_b32 s61, s10
    s_bitset1_b32 s69, s10
    s_lshl_b32 s10, s10, 10
    s_add_u32 s11, s10, s93
    v_add_u32 v162, s10, v161
    buffer_load_dwordx4 v[32:35], v163, s[48:51], s11 offen sc1
    ds_read_b64_tr_b16 v[96:97], v162
    ds_read_b64_tr_b16 v[98:99], v162 offset:512
L_is5:
    s_ff1_i32_b32 s10, s61
    s_bitset0_b32 s61, s10
    s_bitset1_b32 s69, s10
    s_lshl_b32 s10, s10, 10
    s_add_u32 s11, s10, s93
    v_add_u32 v162, s10, v161
    buffer_load_dwordx4 v[36:39], v163, s[48:51], s11 offen sc1
    ds_read_b64_tr_b16 v[100:101], v162
    ds_read_b64_tr_b16 v[102:103], v162 offset:512
L_is6:
    s_ff1_i32_b32 s10, s61
    s_bitset0_b32 s61, s10
    s_bitset1_b32 s69, s10
    s_lshl_b32 s10, s10, 10
    s_add_u32 s11, s10, s93
    v_add_u32 v162, s10, v161
    buffer_load_dwordx4 v[40:43], v163, s[48:51], s11 offen sc1
    ds_read_b64_tr_b16 v[104:105], v162
    ds_read_b64_tr_b16 v[106:107], v162 offset:512
L_is7:
    s_ff1_i32_b32 s10, s61
    s_bitset0_b32 s61, s10
    s_bitset1_b32 s69, s10
    s_lshl_b32 s10, s10, 10
    s_add_u32 s11, s10, s93
    v_add_u32 v162, s10, v161
    buffer_load_dwordx4 v[44:47], v163, s[48:51], s11 offen sc1
    ds_read_b64_tr_b16 v[108:109], v162
    ds_read_b64_tr_b16 v[110:111], v162 offset:512
L_is8:
    s_ff1_i32_b32 s10, s61
    s_bitset0_b32 s61, s10
    s_bitset1_b32 s69, s10
    s_lshl_b32 s10, s10, 10
    s_add_u32 s11, s10, s93
    v_add_u32 v162, s10, v161
    buffer_load_dwordx4 v[48:51], v163, s[48:51], s11 offen sc1
    ds_read_b64_tr_b16 v[112:113], v162
    ds_read_b64_tr_b16 v[114:115], v162 offset:512
L_is9:
    s_ff1_i32_b32 s10, s61
    s_bitset0_b32 s61, s10
    s_bitset1_b32 s69, s10
    s_lshl_b32 s10, s10, 10
    s_add_u32 s11, s10, s93
    v_add_u32 v162, s10, v161
    buffer_load_dwordx4 v[52:55], v163, s[48:51], s11 offen sc1
    ds_read_b64_tr_b16 v[116:117], v162
    ds_read_b64_tr_b16 v[118:119], v162 offset:512
L_is10:
    s_ff1_i32_b32 s10, s61
    s_bitset0_b32 s61, s10
    s_bitset1_b32 s69, s10
    s_lshl_b32 s10, s10, 10
    s_add_u32 s11, s10, s93
    v_add_u32 v162, s10, v161
    buffer_load_dwordx4 v[56:59], v163, s[48:51], s11 offen sc1
    ds_read_b64_tr_b16 v[120:121], v162
    ds_read_b64_tr_b16 v[122:123], v162 offset:512
L_is11:
    s_ff1_i32_b32 s10, s61
    s_bitset0_b32 s61, s10
    s_bitset1_b32 s69, s10
    s_lshl_b32 s10, s10, 10
    s_add_u32 s11, s10, s93
    v_add_u32 v162, s10, v161
    buffer_load_dwordx4 v[60:63], v163, s[48:51], s11 offen sc1
    ds_read_b64_tr_b16 v[124:125], v162
    ds_read_b64_tr_b16 v[126:127], v162 offset:512
L_is12:
    s_ff1_i32_b32 s10, s61
    s_bitset0_b32 s61, s10
    s_bitset1_b32 s69, s10
    s_lshl_b32 s10, s10, 10
    s_add_u32 s11, s10, s93
    v_add_u32 v162, s10, v161
    buffer_load_dwordx4 v[64:67], v163, s[48:51], s11 offen sc1
    ds_read_b64_tr_b16 v[128:129], v162
    ds_read_b64_tr_b16 v[130:131], v162 offset:512
L_is13:
    s_ff1_i32_b32 s10, s61
    s_bitset0_b32 s61, s10
    s_bitset1_b32 s69, s10
    s_lshl_b32 s10, s10, 10
    s_add_u32 s11, s10, s93
    v_add_u32 v162, s10, v161
    buffer_load_dwordx4 v[68:71], v163, s[48:51], s11 offen sc1
    ds_read_b64_tr_b16 v[132:133], v162
    ds_read_b64_tr_b16 v[134:135], v162 offset:512
L_is14:
    s_ff1_i32_b32 s10, s61
    s_bitset0_b32 s61, s10
    s_bitset1_b32 s69, s10
    s_lshl_b32 s10, s10, 10
    s_add_u32 s11, s10, s93
    v_add_u32 v162, s10, v161
    buffer_load_dwordx4 v[72:75], v163, s[48:51], s11 offen sc1
    ds_read_b64_tr_b16 v[136:137], v162
    ds_read_b64_tr_b16 v[138:139], v162 offset:512
L_is15:
    s_ff1_i32_b32 s10, s61
    s_bitset0_b32 s61, s10
    s_bitset1_b32 s69, s10
    s_lshl_b32 s10, s10, 10
    s_add_u32 s11, s10, s93
    v_add_u32 v162, s10, v161
    buffer_load_dwordx4 v[76:79], v163, s[48:51], s11 offen sc1
    ds_read_b64_tr_b16 v[140:141], v162
    ds_read_b64_tr_b16 v[142:143], v162 offset:512
    s_not_b32 exec_lo, s69
    s_bitset1_b32 exec_lo, 0
    s_mov_b32 exec_hi, 0
    buffer_load_dword v164, v166, s[48:51], s94 offen sc1
    s_mov_b64 exec, -1
    s_waitcnt lgkmcnt(0)
    s_cmp_ge_u32 s60, 9
    s_cbranch_scc1 tr_28
    s_cmp_ge_u32 s60, 5
    s_cbranch_scc1 tr_29
    s_cmp_ge_u32 s60, 3
    s_cbranch_scc1 tr_30
    s_cmp_lt_u32 s60, 2
    s_cbranch_scc1 L_mm15
    s_branch L_mm14
tr_30:
    s_cmp_lt_u32 s60, 4
    s_cbranch_scc1 L_mm13
    s_branch L_mm12
tr_29:
    s_cmp_ge_u32 s60, 7
    s_cbranch_scc1 tr_31
    s_cmp_lt_u32 s60, 6
    s_cbranch_scc1 L_mm11
    s_branch L_mm10
tr_31:
    s_cmp_lt_u32 s60, 8
    s_cbranch_scc1 L_mm9
    s_branch L_mm8
tr_28:
    s_cmp_ge_u32 s60, 13
    s_cbranch_scc1 tr_32
    s_cmp_ge_u32 s60, 11
    s_cbranch_scc1 tr_33
    s_cmp_lt_u32 s60, 10
    s_cbranch_scc1 L_mm7
    s_branch L_mm6
tr_33:
    s_cmp_lt_u32 s60, 12
    s_cbranch_scc1 L_mm5
    s_branch L_mm4
tr_32:
    s_cmp_ge_u32 s60, 15
    s_cbranch_scc1 tr_34
    s_cmp_lt_u32 s60, 14
    s_cbranch_scc1 L_mm3
    s_branch L_mm2
tr_34:
    s_cmp_lt_u32 s60, 16
    s_cbranch_scc1 L_mm1
L_mm0:
    s_waitcnt vmcnt(16)
    v_mfma_f32_32x32x16_bf16 v[0:15], v[80:83], v[16:19], v[0:15]
L_mm1:
    s_waitcnt vmcnt(15)
    v_mfma_f32_32x32x16_bf16 v[0:15], v[84:87], v[20:23], v[0:15]
L_mm2:
    s_waitcnt vmcnt(14)
    v_mfma_f32_32x32x16_bf16 v[0:15], v[88:91], v[24:27], v[0:15]
L_mm3:
    s_waitcnt vmcnt(13)
    v_mfma_f32_32x32x16_bf16 v[0:15], v[92:95], v[28:31], v[0:15]
L_mm4:
    s_waitcnt vmcnt(12)
    v_mfma_f32_32x32x16_bf16 v[0:15], v[96:99], v[32:35], v[0:15]
L_mm5:
    s_waitcnt vmcnt(11)
    v_mfma_f32_32x32x16_bf16 v[0:15], v[100:103], v[36:39], v[0:15]
L_mm6:
    s_waitcnt vmcnt(10)
    v_mfma_f32_32x32x16_bf16 v[0:15], v[104:107], v[40:43], v[0:15]
L_mm7:
    s_waitcnt vmcnt(9)
    v_mfma_f32_32x32x16_bf16 v[0:15], v[108:111], v[44:47], v[0:15]
L_mm8:
    s_waitcnt vmcnt(8)
    v_mfma_f32_32x32x16_bf16 v[0:15], v[112:115], v[48:51], v[0:15]
L_mm9:
    s_waitcnt vmcnt(7)
    v_mfma_f32_32x32x16_bf16 v[0:15], v[116:119], v[52:55], v[0:15]
L_mm10:
    s_waitcnt vmcnt(6)
    v_mfma_f32_32x32x16_bf16 v[0:15], v[120:123], v[56:59], v[0:15]
L_mm11:
    s_waitcnt vmcnt(5)
    v_mfma_f32_32x32x16_bf16 v[0:15], v[124:127], v[60:63], v[0:15]
L_mm12:
    s_waitcnt vmcnt(4)
    v_mfma_f32_32x32x16_bf16 v[0:15], v[128:131], v[64:67], v[0:15]
L_mm13:
    s_waitcnt vmcnt(3)
    v_mfma_f32_32x32x16_bf16 v[0:15], v[132:135], v[68:71], v[0:15]
L_mm14:
    s_waitcnt vmcnt(2)
    v_mfma_f32_32x32x16_bf16 v[0:15], v[136:139], v[72:75], v[0:15]
L_mm15:
    s_waitcnt vmcnt(1)
    v_mfma_f32_32x32x16_bf16 v[0:15], v[140:143], v[76:79], v[0:15]
    s_cmp_lg_u32 s69, -1
    s_cbranch_scc1 L_ev2
    s_branch L_final
L_more:
    s_sleep 1
    s_cmp_lt_u32 s95, 40000
    s_cbranch_scc1 L_ev
L_final:
    s_nop 8
    v_pk_fma_f32 v[0:1], v[0:1], v[160:161], v[144:145] op_sel_hi:[1,0,1]
    v_pk_fma_f32 v[2:3], v[2:3], v[160:161], v[146:147] op_sel_hi:[1,0,1]
    v_pk_fma_f32 v[4:5], v[4:5], v[160:161], v[148:149] op_sel_hi:[1,0,1]
    v_pk_fma_f32 v[6:7], v[6:7], v[160:161], v[150:151] op_sel_hi:[1,0,1]
    v_pk_fma_f32 v[8:9], v[8:9], v[160:161], v[152:153] op_sel_hi:[1,0,1]
    v_pk_fma_f32 v[10:11], v[10:11], v[160:161], v[154:155] op_sel_hi:[1,0,1]
    v_pk_fma_f32 v[12:13], v[12:13], v[160:161], v[156:157] op_sel_hi:[1,0,1]
    v_pk_fma_f32 v[14:15], v[14:15], v[160:161], v[158:159] op_sel_hi:[1,0,1]
    v_cvt_pk_bf16_f32 v16, v0, v1
    v_cvt_pk_bf16_f32 v17, v2, v3
    v_cvt_pk_bf16_f32 v18, v4, v5
    v_cvt_pk_bf16_f32 v19, v6, v7
    v_cvt_pk_bf16_f32 v20, v8, v9
    v_cvt_pk_bf16_f32 v21, v10, v11
    v_cvt_pk_bf16_f32 v22, v12, v13
    v_cvt_pk_bf16_f32 v23, v14, v15
    buffer_store_dwordx4 v[16:19], v165, s[52:55], s92 offen
    buffer_store_dwordx4 v[20:23], v165, s[52:55], s92 offen offset:32
    s_branch L_exit
L_exit:
L_end:
    s_endpgm
.section .rodata,"a"
.p2align 6
.amdhsa_kernel gated_mix__mha_block__moe_arch_mod__prompt_kernel
  .amdhsa_next_free_vgpr 168
  .amdhsa_next_free_sgpr 96
  .amdhsa_accum_offset 168
  .amdhsa_group_segment_fixed_size 0
  .amdhsa_kernarg_size 96
  .amdhsa_user_sgpr_count 2
  .amdhsa_user_sgpr_kernarg_segment_ptr 1
  .amdhsa_system_sgpr_workgroup_id_x 1
.end_amdhsa_kernel
```
